```python
import torch

def _softmax(x, axis=-1):
    return torch.softmax(x, dim=axis)
def _gelu(x):
    return torch.nn.functional.gelu(x, approximate="tanh")
def _silu(x):
    return torch.nn.functional.silu(x)
def _sigmoid(x):
    return torch.sigmoid(x)
def _layernorm(x, axis=-1, eps=1e-5):
    m = x.mean(dim=axis, keepdim=True)
    v = x.var(dim=axis, keepdim=True, unbiased=False)
    return (x - m) / torch.sqrt(v + eps)
def _scatter_add(tgt, idx, src, axis=0):
    return tgt.clone().index_add_(axis, idx, src)
def _segment_sum(src, seg, n):
    out = torch.zeros((n,) + src.shape[1:], dtype=src.dtype)
    return out.index_add_(0, seg, src)
def _pad(x, pw):
    flat = tuple(v for pair in reversed(pw) for v in pair)
    return torch.nn.functional.pad(x, flat)

kernel_name = 'standalone__cheap_equivariant_egnn__graph'

def setup_inputs():

    _w = (lambda a: (lambda t: t.to(torch.bfloat16) if t.is_floating_point() else t)(torch.as_tensor(a)))
    N, deg, D, De = 12500, 32, 128, max(4, 1)
    E = N * deg
    return {
        "h": _w((lambda *s: torch.randn(*s, dtype=torch.bfloat16) * 0.1)(N, D)),
        "pos": _w((lambda *s: torch.randn(*s, dtype=torch.bfloat16) * 0.8)(N, 3)),
        "e_attr": _w((lambda *s: torch.randn(*s, dtype=torch.bfloat16) * 0.8)(E, De)),
        "src": _w((lambda lo, hi, *s: torch.randint(lo, hi, s))(0, N, E).to(torch.int64)),
        "dst": _w((lambda lo, hi, *s: torch.randint(lo, hi, s))(0, N, E).to(torch.int64)),
        "w_e": _w(0.1 * (lambda *s: torch.randn(*s, dtype=torch.bfloat16) * 0.8)(2 * D + 1 + De, D)),
        "w_x": _w(0.1 * (lambda *s: torch.randn(*s, dtype=torch.bfloat16) * 0.1)(D, 1)),
        "w_h": _w(0.1 * (lambda *s: torch.randn(*s, dtype=torch.bfloat16) * 0.1)(2 * D, D)),
    }

def reference(h, pos, e_attr, src, dst, w_e, w_x, w_h):
    N, D = h.shape[0], h.shape[1]
    diff = pos[dst] - pos[src]
    dist2 = torch.sum(diff * diff, axis=-1, keepdims=True)
    e_in = torch.concatenate([h[dst], h[src], dist2, e_attr], axis=-1)
    m_ij = _silu(e_in @ w_e)
    coord_scale = m_ij @ w_x
    pos_new = pos + _segment_sum(diff * coord_scale, dst, N)
    m_i = _segment_sum(m_ij, dst, N)
    h_new = h + _silu(torch.concatenate([h, m_i], axis=-1) @ w_h)
    return h_new, pos_new
```

```asm
; @launch kernel=egnn_prep_kernel grid=(239,1,1) block=(512,1,1) lds=90368
; @launch kernel=standalone__cheap_equivariant_egnn__graph_kernel grid=(256,1,1) block=(512,1,1) lds=133376
.amdgcn_target "amdgcn-amd-amdhsa--gfx950"
.text
.globl egnn_prep_kernel
.p2align 8
.type egnn_prep_kernel,@function
egnn_prep_kernel:
    s_cmp_ge_u32 s2, 239
    s_cbranch_scc1 K1_EXIT
    s_cmp_lt_u32 s2, 128
    s_cbranch_scc1 K1_SORT
    s_cmp_lt_u32 s2, 226
    s_cbranch_scc1 K1_GEMM
    s_branch K1_WPREP
K1_EXIT:
    s_endpgm
K1_SORT:
    s_load_dwordx4 s[44:47], s[0:1], 8
    s_load_dwordx4 s[48:51], s[0:1], 24
    s_load_dwordx2 s[52:53], s[0:1], 80
    s_waitcnt lgkmcnt(0)
    s_mov_b32 s8, s44
    s_mov_b32 s9, s45
    s_mov_b32 s10, 0x124f8
    s_mov_b32 s11, 0x20000
    s_mov_b32 s12, s46
    s_mov_b32 s13, s47
    s_mov_b32 s14, 0x30d400
    s_mov_b32 s15, 0x20000
    s_mov_b32 s16, s48
    s_mov_b32 s17, s49
    s_mov_b32 s18, 0x186a00
    s_mov_b32 s19, 0x20000
    s_mov_b32 s20, s50
    s_mov_b32 s21, s51
    s_mov_b32 s22, 0x186a00
    s_mov_b32 s23, 0x20000
    s_mov_b32 s24, s52
    s_mov_b32 s25, s53
    s_mov_b32 s26, 0x61a800
    s_mov_b32 s27, 0x20000
    s_add_u32 s28, s52, 0x640000
    s_addc_u32 s29, s53, 0
    s_mov_b32 s30, 0x186a00
    s_mov_b32 s31, 0x20000
    s_add_u32 s32, s52, 0x800000
    s_addc_u32 s33, s53, 0
    s_mov_b32 s34, 0x100000
    s_mov_b32 s35, 0x20000
    s_mul_i32 s36, s2, 3125
    s_add_u32 s54, s36, 0
    s_lshl_b32 s62, s54, 3
    s_lshl_b32 s54, s54, 2
    s_add_u32 s55, s36, 512
    s_lshl_b32 s63, s55, 3
    s_lshl_b32 s55, s55, 2
    s_add_u32 s56, s36, 1024
    s_lshl_b32 s64, s56, 3
    s_lshl_b32 s56, s56, 2
    s_add_u32 s57, s36, 1536
    s_lshl_b32 s65, s57, 3
    s_lshl_b32 s57, s57, 2
    s_add_u32 s58, s36, 2048
    s_lshl_b32 s66, s58, 3
    s_lshl_b32 s58, s58, 2
    s_add_u32 s59, s36, 2560
    s_lshl_b32 s67, s59, 3
    s_lshl_b32 s59, s59, 2
    s_add_u32 s60, s36, 3072
    s_lshl_b32 s68, s60, 3
    s_lshl_b32 s60, s60, 2
    v_lshlrev_b32 v1, 2, v0
    v_lshlrev_b32 v2, 3, v0
    v_lshlrev_b32 v3, 4, v0
    v_mov_b32 v4, v3
    buffer_load_dword v5, v1, s[20:23], s54 offen
    buffer_load_dword v6, v1, s[20:23], s55 offen
    buffer_load_dword v7, v1, s[20:23], s56 offen
    buffer_load_dword v8, v1, s[20:23], s57 offen
    buffer_load_dword v9, v1, s[20:23], s58 offen
    buffer_load_dword v10, v1, s[20:23], s59 offen
    buffer_load_dword v11, v1, s[20:23], s60 offen
    buffer_load_dword v12, v1, s[16:19], s54 offen
    buffer_load_dword v13, v1, s[16:19], s55 offen
    buffer_load_dword v14, v1, s[16:19], s56 offen
    buffer_load_dword v15, v1, s[16:19], s57 offen
    buffer_load_dword v16, v1, s[16:19], s58 offen
    buffer_load_dword v17, v1, s[16:19], s59 offen
    buffer_load_dword v18, v1, s[16:19], s60 offen
    s_mov_b32 s70, 0
    buffer_load_dwordx4 v[36:39], v3, s[8:11], s70 offen
    s_mov_b32 s70, 8192
    buffer_load_dwordx4 v[40:43], v3, s[8:11], s70 offen
    s_mov_b32 s70, 16384
    buffer_load_dwordx4 v[44:47], v3, s[8:11], s70 offen
    s_mov_b32 s70, 24576
    buffer_load_dwordx4 v[48:51], v3, s[8:11], s70 offen
    s_mov_b32 s70, 32768
    buffer_load_dwordx4 v[52:55], v3, s[8:11], s70 offen
    s_mov_b32 s70, 40960
    buffer_load_dwordx4 v[56:59], v3, s[8:11], s70 offen
    s_mov_b32 s70, 49152
    buffer_load_dwordx4 v[60:63], v3, s[8:11], s70 offen
    s_mov_b32 s70, 57344
    buffer_load_dwordx4 v[64:67], v3, s[8:11], s70 offen
    s_mov_b32 s70, 65536
    buffer_load_dwordx4 v[68:71], v3, s[8:11], s70 offen
    s_mov_b32 s70, 73728
    buffer_load_dwordx4 v[72:75], v3, s[8:11], s70 offen
    buffer_load_dwordx2 v[20:21], v2, s[12:15], s62 offen
    buffer_load_dwordx2 v[22:23], v2, s[12:15], s63 offen
    buffer_load_dwordx2 v[24:25], v2, s[12:15], s64 offen
    buffer_load_dwordx2 v[26:27], v2, s[12:15], s65 offen
    buffer_load_dwordx2 v[28:29], v2, s[12:15], s66 offen
    buffer_load_dwordx2 v[30:31], v2, s[12:15], s67 offen
    buffer_load_dwordx2 v[32:33], v2, s[12:15], s68 offen
    v_mov_b32 v76, 0
    v_mov_b32 v77, 0
    v_mov_b32 v78, 0
    v_mov_b32 v79, 0
    ds_write_b128 v4, v[76:79]
    v_mov_b32 v19, 1
    v_mov_b32 v34, 8192
    ds_write_b128 v34, v[76:79]
    v_cmp_gt_u32 s[72:73], 53, v0
    s_waitcnt lgkmcnt(0)
    s_barrier
    s_mov_b32 s74, 0x14f8b59
    s_movk_i32 s75, 0x1ff
    s_waitcnt vmcnt(30)
    v_lshl_or_b32 v101, v5, 9, s75
    v_mul_hi_u32 v101, v101, s74
    v_lshrrev_b32 v101, 4, v101
    v_mul_u32_u24 v102, 0xc35, v101
    v_lshrrev_b32 v102, 9, v102
    v_sub_u32 v102, v5, v102
    v_lshlrev_b32 v87, 2, v101
    ds_add_rtn_u32 v94, v87, v19
    v_lshlrev_b32 v80, 5, v102
    s_waitcnt vmcnt(29)
    v_lshl_or_b32 v101, v6, 9, s75
    v_mul_hi_u32 v101, v101, s74
    v_lshrrev_b32 v101, 4, v101
    v_mul_u32_u24 v102, 0xc35, v101
    v_lshrrev_b32 v102, 9, v102
    v_sub_u32 v102, v6, v102
    v_lshlrev_b32 v88, 2, v101
    ds_add_rtn_u32 v95, v88, v19
    v_lshlrev_b32 v81, 5, v102
    s_waitcnt vmcnt(28)
    v_lshl_or_b32 v101, v7, 9, s75
    v_mul_hi_u32 v101, v101, s74
    v_lshrrev_b32 v101, 4, v101
    v_mul_u32_u24 v102, 0xc35, v101
    v_lshrrev_b32 v102, 9, v102
    v_sub_u32 v102, v7, v102
    v_lshlrev_b32 v89, 2, v101
    ds_add_rtn_u32 v96, v89, v19
    v_lshlrev_b32 v82, 5, v102
    s_waitcnt vmcnt(27)
    v_lshl_or_b32 v101, v8, 9, s75
    v_mul_hi_u32 v101, v101, s74
    v_lshrrev_b32 v101, 4, v101
    v_mul_u32_u24 v102, 0xc35, v101
    v_lshrrev_b32 v102, 9, v102
    v_sub_u32 v102, v8, v102
    v_lshlrev_b32 v90, 2, v101
    ds_add_rtn_u32 v97, v90, v19
    v_lshlrev_b32 v83, 5, v102
    s_waitcnt vmcnt(26)
    v_lshl_or_b32 v101, v9, 9, s75
    v_mul_hi_u32 v101, v101, s74
    v_lshrrev_b32 v101, 4, v101
    v_mul_u32_u24 v102, 0xc35, v101
    v_lshrrev_b32 v102, 9, v102
    v_sub_u32 v102, v9, v102
    v_lshlrev_b32 v91, 2, v101
    ds_add_rtn_u32 v98, v91, v19
    v_lshlrev_b32 v84, 5, v102
    s_waitcnt vmcnt(25)
    v_lshl_or_b32 v101, v10, 9, s75
    v_mul_hi_u32 v101, v101, s74
    v_lshrrev_b32 v101, 4, v101
    v_mul_u32_u24 v102, 0xc35, v101
    v_lshrrev_b32 v102, 9, v102
    v_sub_u32 v102, v10, v102
    v_lshlrev_b32 v92, 2, v101
    ds_add_rtn_u32 v99, v92, v19
    v_lshlrev_b32 v85, 5, v102
    s_waitcnt vmcnt(24)
    v_lshl_or_b32 v101, v11, 9, s75
    v_mul_hi_u32 v101, v101, s74
    v_lshrrev_b32 v101, 4, v101
    v_mul_u32_u24 v102, 0xc35, v101
    v_lshrrev_b32 v102, 9, v102
    v_sub_u32 v102, v11, v102
    v_lshlrev_b32 v93, 2, v101
    v_mov_b32 v101, 8192
    v_cndmask_b32 v93, v101, v93, s[72:73]
    ds_add_rtn_u32 v100, v93, v19
    v_lshlrev_b32 v86, 5, v102
    v_add_u32 v34, 8448, v3
    s_waitcnt vmcnt(16)
    ds_write_b128 v34, v[36:39] offset:0
    s_waitcnt vmcnt(15)
    ds_write_b128 v34, v[40:43] offset:8192
    s_waitcnt vmcnt(14)
    ds_write_b128 v34, v[44:47] offset:16384
    s_waitcnt vmcnt(13)
    ds_write_b128 v34, v[48:51] offset:24576
    s_waitcnt vmcnt(12)
    ds_write_b128 v34, v[52:55] offset:32768
    s_waitcnt vmcnt(11)
    ds_write_b128 v34, v[56:59] offset:40960
    s_waitcnt vmcnt(10)
    ds_write_b128 v34, v[60:63] offset:49152
    s_waitcnt vmcnt(9)
    ds_write_b128 v34, v[64:67] offset:57344
    v_add_u32 v35, 73984, v3
    s_waitcnt vmcnt(8)
    ds_write_b128 v35, v[68:71] offset:0
    s_waitcnt vmcnt(7)
    ds_write_b128 v35, v[72:75] offset:8192
    s_waitcnt lgkmcnt(0)
    s_barrier
    ds_read_b128 v[148:151], v4
    v_mul_u32_u24 v101, 6, v5
    v_mul_u32_u24 v102, 6, v12
    ds_read_u16 v103, v101 offset:8448
    ds_read_u16 v104, v101 offset:8450
    ds_read_u16 v105, v101 offset:8452
    ds_read_u16 v106, v102 offset:8448
    ds_read_u16 v107, v102 offset:8450
    ds_read_u16 v108, v102 offset:8452
    v_lshl_add_u32 v80, v12, 8, v80
    v_mul_u32_u24 v101, 6, v6
    v_mul_u32_u24 v102, 6, v13
    ds_read_u16 v109, v101 offset:8448
    ds_read_u16 v110, v101 offset:8450
    ds_read_u16 v111, v101 offset:8452
    ds_read_u16 v112, v102 offset:8448
    ds_read_u16 v113, v102 offset:8450
    ds_read_u16 v114, v102 offset:8452
    v_lshl_add_u32 v81, v13, 8, v81
    v_mul_u32_u24 v101, 6, v7
    v_mul_u32_u24 v102, 6, v14
    ds_read_u16 v115, v101 offset:8448
    ds_read_u16 v116, v101 offset:8450
    ds_read_u16 v117, v101 offset:8452
    ds_read_u16 v118, v102 offset:8448
    ds_read_u16 v119, v102 offset:8450
    ds_read_u16 v120, v102 offset:8452
    v_lshl_add_u32 v82, v14, 8, v82
    v_mul_u32_u24 v101, 6, v8
    v_mul_u32_u24 v102, 6, v15
    ds_read_u16 v121, v101 offset:8448
    ds_read_u16 v122, v101 offset:8450
    ds_read_u16 v123, v101 offset:8452
    ds_read_u16 v124, v102 offset:8448
    ds_read_u16 v125, v102 offset:8450
    ds_read_u16 v126, v102 offset:8452
    v_lshl_add_u32 v83, v15, 8, v83
    v_mul_u32_u24 v101, 6, v9
    v_mul_u32_u24 v102, 6, v16
    ds_read_u16 v127, v101 offset:8448
    ds_read_u16 v128, v101 offset:8450
    ds_read_u16 v129, v101 offset:8452
    ds_read_u16 v130, v102 offset:8448
    ds_read_u16 v131, v102 offset:8450
    ds_read_u16 v132, v102 offset:8452
    v_lshl_add_u32 v84, v16, 8, v84
    v_mul_u32_u24 v101, 6, v10
    v_mul_u32_u24 v102, 6, v17
    ds_read_u16 v133, v101 offset:8448
    ds_read_u16 v134, v101 offset:8450
    ds_read_u16 v135, v101 offset:8452
    ds_read_u16 v136, v102 offset:8448
    ds_read_u16 v137, v102 offset:8450
    ds_read_u16 v138, v102 offset:8452
    v_lshl_add_u32 v85, v17, 8, v85
    v_mul_u32_u24 v101, 6, v11
    v_mul_u32_u24 v102, 6, v18
    ds_read_u16 v139, v101 offset:8448
    ds_read_u16 v140, v101 offset:8450
    ds_read_u16 v141, v101 offset:8452
    ds_read_u16 v142, v102 offset:8448
    ds_read_u16 v143, v102 offset:8450
    ds_read_u16 v144, v102 offset:8452
    v_lshl_add_u32 v86, v18, 8, v86
    v_mov_b32 v152, 0
    s_waitcnt lgkmcnt(15)
    v_add_u32 v153, v152, v148
    v_add_u32 v154, v153, v149
    v_add_u32 v155, v154, v150
    v_add_u32 v145, v155, v151
    v_mov_b32 v146, v145
    s_nop 1
    v_add_u32_dpp v146, v146, v146 row_shr:1 row_mask:0xf bank_mask:0xf bound_ctrl:0
    s_nop 1
    v_add_u32_dpp v146, v146, v146 row_shr:2 row_mask:0xf bank_mask:0xf bound_ctrl:0
    s_nop 1
    v_add_u32_dpp v146, v146, v146 row_shr:4 row_mask:0xf bank_mask:0xf bound_ctrl:0
    s_nop 1
    v_add_u32_dpp v146, v146, v146 row_shr:8 row_mask:0xf bank_mask:0xf bound_ctrl:0
    s_nop 1
    v_add_u32_dpp v146, v146, v146 row_bcast:15 row_mask:0xa bank_mask:0xf
    s_nop 1
    v_add_u32_dpp v146, v146, v146 row_bcast:31 row_mask:0xc bank_mask:0xf
    v_lshrrev_b32 v101, 6, v0
    s_nop 0
    v_readfirstlane_b32 s76, v101
    v_readlane_b32 s77, v146, 63
    v_lshlrev_b32 v101, 2, v101
    v_add_u32 v101, 8224, v101
    v_mov_b32 v102, s77
    ds_write_b32 v101, v102
    v_mov_b32 v173, 0xffff0000
    v_lshlrev_b32 v103, 16, v103
    v_lshlrev_b32 v104, 16, v104
    v_lshlrev_b32 v105, 16, v105
    v_lshlrev_b32 v106, 16, v106
    v_lshlrev_b32 v107, 16, v107
    v_lshlrev_b32 v108, 16, v108
    v_sub_f32 v103, v103, v106
    v_sub_f32 v104, v104, v107
    v_sub_f32 v105, v105, v108
    v_cvt_pk_bf16_f32 v169, v103, v104
    v_cvt_pk_bf16_f32 v170, v105, v105
    v_lshlrev_b32 v103, 16, v169
    v_and_b32 v104, v173, v169
    v_lshlrev_b32 v105, 16, v170
    v_mul_f32 v103, v103, v103
    v_mul_f32 v104, v104, v104
    v_mul_f32 v105, v105, v105
    v_cvt_pk_bf16_f32 v171, v103, v104
    v_cvt_pk_bf16_f32 v172, v105, v105
    v_lshlrev_b32 v103, 16, v171
    v_and_b32 v104, v173, v171
    v_lshlrev_b32 v105, 16, v172
    v_add_f32 v103, v103, v104
    v_add_f32 v103, v103, v105
    v_cvt_pk_bf16_f32 v171, v103, v103
    v_and_b32 v171, 0xffff, v171
    v_lshl_or_b32 v147, v169, 16, v171
    v_lshrrev_b32 v169, 16, v169
    v_lshl_or_b32 v162, v170, 16, v169
    v_lshlrev_b32 v109, 16, v109
    v_lshlrev_b32 v110, 16, v110
    v_lshlrev_b32 v111, 16, v111
    v_lshlrev_b32 v112, 16, v112
    v_lshlrev_b32 v113, 16, v113
    v_lshlrev_b32 v114, 16, v114
    v_sub_f32 v109, v109, v112
    v_sub_f32 v110, v110, v113
    v_sub_f32 v111, v111, v114
    v_cvt_pk_bf16_f32 v169, v109, v110
    v_cvt_pk_bf16_f32 v170, v111, v111
    v_lshlrev_b32 v109, 16, v169
    v_and_b32 v110, v173, v169
    v_lshlrev_b32 v111, 16, v170
    v_mul_f32 v109, v109, v109
    v_mul_f32 v110, v110, v110
    v_mul_f32 v111, v111, v111
    v_cvt_pk_bf16_f32 v171, v109, v110
    v_cvt_pk_bf16_f32 v172, v111, v111
    v_lshlrev_b32 v109, 16, v171
    v_and_b32 v110, v173, v171
    v_lshlrev_b32 v111, 16, v172
    v_add_f32 v109, v109, v110
    v_add_f32 v109, v109, v111
    v_cvt_pk_bf16_f32 v171, v109, v109
    v_and_b32 v171, 0xffff, v171
    v_lshl_or_b32 v156, v169, 16, v171
    v_lshrrev_b32 v169, 16, v169
    v_lshl_or_b32 v163, v170, 16, v169
    v_lshlrev_b32 v115, 16, v115
    v_lshlrev_b32 v116, 16, v116
    v_lshlrev_b32 v117, 16, v117
    v_lshlrev_b32 v118, 16, v118
    v_lshlrev_b32 v119, 16, v119
    v_lshlrev_b32 v120, 16, v120
    v_sub_f32 v115, v115, v118
    v_sub_f32 v116, v116, v119
    v_sub_f32 v117, v117, v120
    v_cvt_pk_bf16_f32 v169, v115, v116
    v_cvt_pk_bf16_f32 v170, v117, v117
    v_lshlrev_b32 v115, 16, v169
    v_and_b32 v116, v173, v169
    v_lshlrev_b32 v117, 16, v170
    v_mul_f32 v115, v115, v115
    v_mul_f32 v116, v116, v116
    v_mul_f32 v117, v117, v117
    v_cvt_pk_bf16_f32 v171, v115, v116
    v_cvt_pk_bf16_f32 v172, v117, v117
    v_lshlrev_b32 v115, 16, v171
    v_and_b32 v116, v173, v171
    v_lshlrev_b32 v117, 16, v172
    v_add_f32 v115, v115, v116
    v_add_f32 v115, v115, v117
    v_cvt_pk_bf16_f32 v171, v115, v115
    v_and_b32 v171, 0xffff, v171
    v_lshl_or_b32 v157, v169, 16, v171
    v_lshrrev_b32 v169, 16, v169
    v_lshl_or_b32 v164, v170, 16, v169
    v_lshlrev_b32 v121, 16, v121
    v_lshlrev_b32 v122, 16, v122
    v_lshlrev_b32 v123, 16, v123
    v_lshlrev_b32 v124, 16, v124
    v_lshlrev_b32 v125, 16, v125
    v_lshlrev_b32 v126, 16, v126
    v_sub_f32 v121, v121, v124
    v_sub_f32 v122, v122, v125
    v_sub_f32 v123, v123, v126
    v_cvt_pk_bf16_f32 v169, v121, v122
    v_cvt_pk_bf16_f32 v170, v123, v123
    v_lshlrev_b32 v121, 16, v169
    v_and_b32 v122, v173, v169
    v_lshlrev_b32 v123, 16, v170
    v_mul_f32 v121, v121, v121
    v_mul_f32 v122, v122, v122
    v_mul_f32 v123, v123, v123
    v_cvt_pk_bf16_f32 v171, v121, v122
    v_cvt_pk_bf16_f32 v172, v123, v123
    v_lshlrev_b32 v121, 16, v171
    v_and_b32 v122, v173, v171
    v_lshlrev_b32 v123, 16, v172
    v_add_f32 v121, v121, v122
    v_add_f32 v121, v121, v123
    v_cvt_pk_bf16_f32 v171, v121, v121
    v_and_b32 v171, 0xffff, v171
    v_lshl_or_b32 v158, v169, 16, v171
    v_lshrrev_b32 v169, 16, v169
    v_lshl_or_b32 v165, v170, 16, v169
    v_lshlrev_b32 v127, 16, v127
    v_lshlrev_b32 v128, 16, v128
    v_lshlrev_b32 v129, 16, v129
    s_waitcnt lgkmcnt(15)
    v_lshlrev_b32 v130, 16, v130
    s_waitcnt lgkmcnt(14)
    v_lshlrev_b32 v131, 16, v131
    s_waitcnt lgkmcnt(13)
    v_lshlrev_b32 v132, 16, v132
    v_sub_f32 v127, v127, v130
    v_sub_f32 v128, v128, v131
    v_sub_f32 v129, v129, v132
    v_cvt_pk_bf16_f32 v169, v127, v128
    v_cvt_pk_bf16_f32 v170, v129, v129
    v_lshlrev_b32 v127, 16, v169
    v_and_b32 v128, v173, v169
    v_lshlrev_b32 v129, 16, v170
    v_mul_f32 v127, v127, v127
    v_mul_f32 v128, v128, v128
    v_mul_f32 v129, v129, v129
    v_cvt_pk_bf16_f32 v171, v127, v128
    v_cvt_pk_bf16_f32 v172, v129, v129
    v_lshlrev_b32 v127, 16, v171
    v_and_b32 v128, v173, v171
    v_lshlrev_b32 v129, 16, v172
    v_add_f32 v127, v127, v128
    v_add_f32 v127, v127, v129
    v_cvt_pk_bf16_f32 v171, v127, v127
    v_and_b32 v171, 0xffff, v171
    v_lshl_or_b32 v159, v169, 16, v171
    v_lshrrev_b32 v169, 16, v169
    v_lshl_or_b32 v166, v170, 16, v169
    s_waitcnt lgkmcnt(12)
    v_lshlrev_b32 v133, 16, v133
    s_waitcnt lgkmcnt(11)
    v_lshlrev_b32 v134, 16, v134
    s_waitcnt lgkmcnt(10)
    v_lshlrev_b32 v135, 16, v135
    s_waitcnt lgkmcnt(9)
    v_lshlrev_b32 v136, 16, v136
    s_waitcnt lgkmcnt(8)
    v_lshlrev_b32 v137, 16, v137
    s_waitcnt lgkmcnt(7)
    v_lshlrev_b32 v138, 16, v138
    v_sub_f32 v133, v133, v136
    v_sub_f32 v134, v134, v137
    v_sub_f32 v135, v135, v138
    v_cvt_pk_bf16_f32 v169, v133, v134
    v_cvt_pk_bf16_f32 v170, v135, v135
    v_lshlrev_b32 v133, 16, v169
    v_and_b32 v134, v173, v169
    v_lshlrev_b32 v135, 16, v170
    v_mul_f32 v133, v133, v133
    v_mul_f32 v134, v134, v134
    v_mul_f32 v135, v135, v135
    v_cvt_pk_bf16_f32 v171, v133, v134
    v_cvt_pk_bf16_f32 v172, v135, v135
    v_lshlrev_b32 v133, 16, v171
    v_and_b32 v134, v173, v171
    v_lshlrev_b32 v135, 16, v172
    v_add_f32 v133, v133, v134
    v_add_f32 v133, v133, v135
    v_cvt_pk_bf16_f32 v171, v133, v133
    v_and_b32 v171, 0xffff, v171
    v_lshl_or_b32 v160, v169, 16, v171
    v_lshrrev_b32 v169, 16, v169
    v_lshl_or_b32 v167, v170, 16, v169
    s_waitcnt lgkmcnt(6)
    v_lshlrev_b32 v139, 16, v139
    s_waitcnt lgkmcnt(5)
    v_lshlrev_b32 v140, 16, v140
    s_waitcnt lgkmcnt(4)
    v_lshlrev_b32 v141, 16, v141
    s_waitcnt lgkmcnt(3)
    v_lshlrev_b32 v142, 16, v142
    s_waitcnt lgkmcnt(2)
    v_lshlrev_b32 v143, 16, v143
    s_waitcnt lgkmcnt(1)
    v_lshlrev_b32 v144, 16, v144
    v_sub_f32 v139, v139, v142
    v_sub_f32 v140, v140, v143
    v_sub_f32 v141, v141, v144
    v_cvt_pk_bf16_f32 v169, v139, v140
    v_cvt_pk_bf16_f32 v170, v141, v141
    v_lshlrev_b32 v139, 16, v169
    v_and_b32 v140, v173, v169
    v_lshlrev_b32 v141, 16, v170
    v_mul_f32 v139, v139, v139
    v_mul_f32 v140, v140, v140
    v_mul_f32 v141, v141, v141
    v_cvt_pk_bf16_f32 v171, v139, v140
    v_cvt_pk_bf16_f32 v172, v141, v141
    v_lshlrev_b32 v139, 16, v171
    v_and_b32 v140, v173, v171
    v_lshlrev_b32 v141, 16, v172
    v_add_f32 v139, v139, v140
    v_add_f32 v139, v139, v141
    v_cvt_pk_bf16_f32 v171, v139, v139
    v_and_b32 v171, 0xffff, v171
    v_lshl_or_b32 v161, v169, 16, v171
    v_lshrrev_b32 v169, 16, v169
    v_lshl_or_b32 v168, v170, 16, v169
    s_waitcnt lgkmcnt(0)
    s_barrier
    v_mov_b32 v101, 8224
    ds_read_b128 v[176:179], v101 offset:0
    ds_read_b128 v[180:183], v101 offset:16
    v_sub_u32 v146, v146, v145
    s_cmp_gt_u32 s76, 0
    s_cselect_b64 s[78:79], -1, 0
    s_waitcnt lgkmcnt(1)
    v_cndmask_b32 v102, 0, v176, s[78:79]
    v_add_u32 v146, v146, v102
    s_cmp_gt_u32 s76, 1
    s_cselect_b64 s[78:79], -1, 0
    v_cndmask_b32 v102, 0, v177, s[78:79]
    v_add_u32 v146, v146, v102
    s_cmp_gt_u32 s76, 2
    s_cselect_b64 s[78:79], -1, 0
    v_cndmask_b32 v102, 0, v178, s[78:79]
    v_add_u32 v146, v146, v102
    s_cmp_gt_u32 s76, 3
    s_cselect_b64 s[78:79], -1, 0
    v_cndmask_b32 v102, 0, v179, s[78:79]
    v_add_u32 v146, v146, v102
    s_cmp_gt_u32 s76, 4
    s_cselect_b64 s[78:79], -1, 0
    s_waitcnt lgkmcnt(0)
    v_cndmask_b32 v102, 0, v180, s[78:79]
    v_add_u32 v146, v146, v102
    s_cmp_gt_u32 s76, 5
    s_cselect_b64 s[78:79], -1, 0
    v_cndmask_b32 v102, 0, v181, s[78:79]
    v_add_u32 v146, v146, v102
    s_cmp_gt_u32 s76, 6
    s_cselect_b64 s[78:79], -1, 0
    v_cndmask_b32 v102, 0, v182, s[78:79]
    v_add_u32 v146, v146, v102
    v_add_u32 v152, v152, v146
    v_add_u32 v153, v153, v146
    v_add_u32 v154, v154, v146
    v_add_u32 v155, v155, v146
    ds_write_b128 v4, v[152:155]
    v_lshl_or_b32 v76, v148, 16, v152
    v_lshl_or_b32 v77, v149, 16, v153
    v_lshl_or_b32 v78, v150, 16, v154
    v_lshl_or_b32 v79, v151, 16, v155
    v_lshrrev_b32 v101, 1, v0
    v_lshlrev_b32 v101, 12, v101
    v_and_b32 v102, 1, v0
    v_lshl_add_u32 v101, v102, 4, v101
    s_lshl_b32 s80, s2, 5
    buffer_store_dwordx4 v[76:79], v101, s[32:35], s80 offen
    s_waitcnt lgkmcnt(0)
    s_barrier
    ds_read_b32 v104, v87
    ds_read_b32 v110, v88
    ds_read_b32 v116, v89
    ds_read_b32 v122, v90
    ds_read_b32 v128, v91
    ds_read_b32 v134, v92
    ds_read_b32 v140, v93
    s_waitcnt lgkmcnt(6)
    v_add_u32 v104, v104, v94
    v_lshlrev_b32 v101, 4, v104
    v_lshlrev_b32 v102, 2, v104
    s_waitcnt vmcnt(7)
    v_mov_b32 v176, v20
    v_mov_b32 v177, v21
    v_mov_b32 v178, v147
    v_mov_b32 v179, v162
    ds_write_b128 v101, v[176:179] offset:8448
    ds_write_b32 v102, v80 offset:58496
    s_waitcnt lgkmcnt(7)
    v_add_u32 v110, v110, v95
    v_lshlrev_b32 v101, 4, v110
    v_lshlrev_b32 v102, 2, v110
    s_waitcnt vmcnt(6)
    v_mov_b32 v176, v22
    v_mov_b32 v177, v23
    v_mov_b32 v178, v156
    v_mov_b32 v179, v163
    ds_write_b128 v101, v[176:179] offset:8448
    ds_write_b32 v102, v81 offset:58496
    s_waitcnt lgkmcnt(8)
    v_add_u32 v116, v116, v96
    v_lshlrev_b32 v101, 4, v116
    v_lshlrev_b32 v102, 2, v116
    s_waitcnt vmcnt(5)
    v_mov_b32 v176, v24
    v_mov_b32 v177, v25
    v_mov_b32 v178, v157
    v_mov_b32 v179, v164
    ds_write_b128 v101, v[176:179] offset:8448
    ds_write_b32 v102, v82 offset:58496
    s_waitcnt lgkmcnt(9)
    v_add_u32 v122, v122, v97
    v_lshlrev_b32 v101, 4, v122
    v_lshlrev_b32 v102, 2, v122
    s_waitcnt vmcnt(4)
    v_mov_b32 v176, v26
    v_mov_b32 v177, v27
    v_mov_b32 v178, v158
    v_mov_b32 v179, v165
    ds_write_b128 v101, v[176:179] offset:8448
    ds_write_b32 v102, v83 offset:58496
    s_waitcnt lgkmcnt(10)
    v_add_u32 v128, v128, v98
    v_lshlrev_b32 v101, 4, v128
    v_lshlrev_b32 v102, 2, v128
    s_waitcnt vmcnt(3)
    v_mov_b32 v176, v28
    v_mov_b32 v177, v29
    v_mov_b32 v178, v159
    v_mov_b32 v179, v166
    ds_write_b128 v101, v[176:179] offset:8448
    ds_write_b32 v102, v84 offset:58496
    s_waitcnt lgkmcnt(11)
    v_add_u32 v134, v134, v99
    v_lshlrev_b32 v101, 4, v134
    v_lshlrev_b32 v102, 2, v134
    s_waitcnt vmcnt(2)
    v_mov_b32 v176, v30
    v_mov_b32 v177, v31
    v_mov_b32 v178, v160
    v_mov_b32 v179, v167
    ds_write_b128 v101, v[176:179] offset:8448
    ds_write_b32 v102, v85 offset:58496
    s_waitcnt lgkmcnt(12)
    v_add_u32 v140, v140, v100
    v_lshlrev_b32 v101, 4, v140
    v_lshlrev_b32 v102, 2, v140
    v_mov_b32 v169, 50000
    v_cndmask_b32 v101, v169, v101, s[72:73]
    v_mov_b32 v169, 12516
    v_cndmask_b32 v102, v169, v102, s[72:73]
    s_waitcnt vmcnt(1)
    v_mov_b32 v176, v32
    v_mov_b32 v177, v33
    v_mov_b32 v178, v161
    v_mov_b32 v179, v168
    ds_write_b128 v101, v[176:179] offset:8448
    ds_write_b32 v102, v86 offset:58496
    s_waitcnt lgkmcnt(0)
    s_barrier
    s_lshl_b32 s80, s36, 4
    s_lshl_b32 s81, s36, 2
    v_add_u32 v101, 58496, v1
    ds_read_b128 v[36:39], v3 offset:8448
    ds_read_b32 v103, v101 offset:0
    ds_read_b128 v[40:43], v3 offset:16640
    ds_read_b32 v109, v101 offset:2048
    ds_read_b128 v[44:47], v3 offset:24832
    ds_read_b32 v115, v101 offset:4096
    ds_read_b128 v[48:51], v3 offset:33024
    ds_read_b32 v121, v101 offset:6144
    ds_read_b128 v[52:55], v3 offset:41216
    ds_read_b32 v127, v101 offset:8192
    ds_read_b128 v[56:59], v3 offset:49408
    ds_read_b32 v133, v101 offset:10240
    ds_read_b128 v[60:63], v3 offset:57600
    ds_read_b32 v139, v101 offset:12288
    s_add_u32 s84, s80, 0
    s_add_u32 s85, s81, 0
    s_waitcnt lgkmcnt(13)
    buffer_store_dwordx4 v[36:39], v3, s[24:27], s84 offen
    s_waitcnt lgkmcnt(12)
    buffer_store_dword v103, v1, s[28:31], s85 offen
    s_add_u32 s84, s80, 8192
    s_add_u32 s85, s81, 2048
    s_waitcnt lgkmcnt(11)
    buffer_store_dwordx4 v[40:43], v3, s[24:27], s84 offen
    s_waitcnt lgkmcnt(10)
    buffer_store_dword v109, v1, s[28:31], s85 offen
    s_add_u32 s84, s80, 16384
    s_add_u32 s85, s81, 4096
    s_waitcnt lgkmcnt(9)
    buffer_store_dwordx4 v[44:47], v3, s[24:27], s84 offen
    s_waitcnt lgkmcnt(8)
    buffer_store_dword v115, v1, s[28:31], s85 offen
    s_add_u32 s84, s80, 24576
    s_add_u32 s85, s81, 6144
    s_waitcnt lgkmcnt(7)
    buffer_store_dwordx4 v[48:51], v3, s[24:27], s84 offen
    s_waitcnt lgkmcnt(6)
    buffer_store_dword v121, v1, s[28:31], s85 offen
    s_add_u32 s84, s80, 32768
    s_add_u32 s85, s81, 8192
    s_waitcnt lgkmcnt(5)
    buffer_store_dwordx4 v[52:55], v3, s[24:27], s84 offen
    s_waitcnt lgkmcnt(4)
    buffer_store_dword v127, v1, s[28:31], s85 offen
    s_add_u32 s84, s80, 40960
    s_add_u32 s85, s81, 10240
    s_waitcnt lgkmcnt(3)
    buffer_store_dwordx4 v[56:59], v3, s[24:27], s84 offen
    s_waitcnt lgkmcnt(2)
    buffer_store_dword v133, v1, s[28:31], s85 offen
    s_and_saveexec_b64 s[82:83], s[72:73]
    s_cbranch_execz K1S_end
    s_add_u32 s84, s80, 49152
    s_add_u32 s85, s81, 12288
    s_waitcnt lgkmcnt(1)
    buffer_store_dwordx4 v[60:63], v3, s[24:27], s84 offen
    s_waitcnt lgkmcnt(0)
    buffer_store_dword v139, v1, s[28:31], s85 offen
K1S_end:
    s_mov_b64 exec, -1
    s_endpgm
K1_GEMM:
    s_load_dwordx2 s[44:45], s[0:1], 0
    s_load_dwordx2 s[46:47], s[0:1], 40
    s_load_dwordx2 s[52:53], s[0:1], 80
    s_waitcnt lgkmcnt(0)
    s_mov_b32 s8, s44
    s_mov_b32 s9, s45
    s_mov_b32 s10, 0x30d400
    s_mov_b32 s11, 0x20000
    s_mov_b32 s12, s46
    s_mov_b32 s13, s47
    s_mov_b32 s14, 0x10500
    s_mov_b32 s15, 0x20000
    s_add_u32 s16, s52, 0xa00000
    s_addc_u32 s17, s53, 0
    s_mov_b32 s18, 0x30d400
    s_mov_b32 s19, 0x20000
    v_lshlrev_b32 v6, 4, v0
    s_mov_b32 s20, 32768
    buffer_load_dwordx4 v[8:11], v6, s[12:15], s20 offen
    s_mov_b32 s20, 40960
    buffer_load_dwordx4 v[12:15], v6, s[12:15], s20 offen
    s_mov_b32 s20, 49152
    buffer_load_dwordx4 v[16:19], v6, s[12:15], s20 offen
    s_mov_b32 s20, 57344
    buffer_load_dwordx4 v[20:23], v6, s[12:15], s20 offen
    v_lshrrev_b32 v1, 6, v0
    s_nop 0
    v_readfirstlane_b32 s20, v1
    v_and_b32 v2, 31, v0
    v_bfe_u32 v3, v0, 5, 1
    v_and_b32 v7, 63, v0
    s_sub_u32 s23, s2, 128
    s_lshl_b32 s25, s23, 2
    s_add_u32 s25, s25, s20
    s_lshl_b32 s25, s25, 13
    v_lshlrev_b32 v5, 8, v2
    v_lshl_add_u32 v5, v3, 4, v5
    s_cmp_ge_u32 s20, 4
    s_cbranch_scc1 K1G_noh
    buffer_load_dwordx4 v[24:27], v5, s[8:11], s25 offen offset:0
    buffer_load_dwordx4 v[28:31], v5, s[8:11], s25 offen offset:32
    buffer_load_dwordx4 v[32:35], v5, s[8:11], s25 offen offset:64
    buffer_load_dwordx4 v[36:39], v5, s[8:11], s25 offen offset:96
    buffer_load_dwordx4 v[40:43], v5, s[8:11], s25 offen offset:128
    buffer_load_dwordx4 v[44:47], v5, s[8:11], s25 offen offset:160
    buffer_load_dwordx4 v[48:51], v5, s[8:11], s25 offen offset:192
    buffer_load_dwordx4 v[52:55], v5, s[8:11], s25 offen offset:224
K1G_noh:
    s_waitcnt vmcnt(3)
    ds_write_b128 v6, v[8:11] offset:0
    s_waitcnt vmcnt(2)
    ds_write_b128 v6, v[12:15] offset:8192
    s_waitcnt vmcnt(1)
    ds_write_b128 v6, v[16:19] offset:16384
    s_waitcnt vmcnt(0)
    ds_write_b128 v6, v[20:23] offset:24576
    s_waitcnt lgkmcnt(0)
    s_barrier
    v_lshlrev_b32 v4, 11, v3
    v_lshl_add_u32 v4, v2, 1, v4
    v_lshlrev_b32 v68, 4, v7
    s_add_u32 s26, s20, 0
    s_lshr_b32 s27, s26, 2
    s_lshl_b32 s27, s27, 12
    s_and_b32 s28, s26, 3
    s_lshl_b32 s28, s28, 6
    s_add_u32 s27, s27, s28
    v_add_u32 v5, s27, v4
    ds_read_u16 v56, v5 offset:0
    ds_read_u16 v57, v5 offset:256
    ds_read_u16 v58, v5 offset:512
    ds_read_u16 v59, v5 offset:768
    ds_read_u16 v60, v5 offset:1024
    ds_read_u16 v61, v5 offset:1280
    ds_read_u16 v62, v5 offset:1536
    ds_read_u16 v63, v5 offset:1792
    s_waitcnt lgkmcnt(6)
    v_lshl_or_b32 v64, v57, 16, v56
    s_waitcnt lgkmcnt(4)
    v_lshl_or_b32 v65, v59, 16, v58
    s_waitcnt lgkmcnt(2)
    v_lshl_or_b32 v66, v61, 16, v60
    s_waitcnt lgkmcnt(0)
    v_lshl_or_b32 v67, v63, 16, v62
    s_lshl_b32 s26, s26, 10
    v_add_u32 v5, s26, v68
    ds_write_b128 v5, v[64:67] offset:32768
    s_add_u32 s26, s20, 8
    s_lshr_b32 s27, s26, 2
    s_lshl_b32 s27, s27, 12
    s_and_b32 s28, s26, 3
    s_lshl_b32 s28, s28, 6
    s_add_u32 s27, s27, s28
    v_add_u32 v5, s27, v4
    ds_read_u16 v56, v5 offset:0
    ds_read_u16 v57, v5 offset:256
    ds_read_u16 v58, v5 offset:512
    ds_read_u16 v59, v5 offset:768
    ds_read_u16 v60, v5 offset:1024
    ds_read_u16 v61, v5 offset:1280
    ds_read_u16 v62, v5 offset:1536
    ds_read_u16 v63, v5 offset:1792
    s_waitcnt lgkmcnt(6)
    v_lshl_or_b32 v64, v57, 16, v56
    s_waitcnt lgkmcnt(4)
    v_lshl_or_b32 v65, v59, 16, v58
    s_waitcnt lgkmcnt(2)
    v_lshl_or_b32 v66, v61, 16, v60
    s_waitcnt lgkmcnt(0)
    v_lshl_or_b32 v67, v63, 16, v62
    s_lshl_b32 s26, s26, 10
    v_add_u32 v5, s26, v68
    ds_write_b128 v5, v[64:67] offset:32768
    s_add_u32 s26, s20, 16
    s_lshr_b32 s27, s26, 2
    s_lshl_b32 s27, s27, 12
    s_and_b32 s28, s26, 3
    s_lshl_b32 s28, s28, 6
    s_add_u32 s27, s27, s28
    v_add_u32 v5, s27, v4
    ds_read_u16 v56, v5 offset:0
    ds_read_u16 v57, v5 offset:256
    ds_read_u16 v58, v5 offset:512
    ds_read_u16 v59, v5 offset:768
    ds_read_u16 v60, v5 offset:1024
    ds_read_u16 v61, v5 offset:1280
    ds_read_u16 v62, v5 offset:1536
    ds_read_u16 v63, v5 offset:1792
    s_waitcnt lgkmcnt(6)
    v_lshl_or_b32 v64, v57, 16, v56
    s_waitcnt lgkmcnt(4)
    v_lshl_or_b32 v65, v59, 16, v58
    s_waitcnt lgkmcnt(2)
    v_lshl_or_b32 v66, v61, 16, v60
    s_waitcnt lgkmcnt(0)
    v_lshl_or_b32 v67, v63, 16, v62
    s_lshl_b32 s26, s26, 10
    v_add_u32 v5, s26, v68
    ds_write_b128 v5, v[64:67] offset:32768
    s_add_u32 s26, s20, 24
    s_lshr_b32 s27, s26, 2
    s_lshl_b32 s27, s27, 12
    s_and_b32 s28, s26, 3
    s_lshl_b32 s28, s28, 6
    s_add_u32 s27, s27, s28
    v_add_u32 v5, s27, v4
    ds_read_u16 v56, v5 offset:0
    ds_read_u16 v57, v5 offset:256
    ds_read_u16 v58, v5 offset:512
    ds_read_u16 v59, v5 offset:768
    ds_read_u16 v60, v5 offset:1024
    ds_read_u16 v61, v5 offset:1280
    ds_read_u16 v62, v5 offset:1536
    ds_read_u16 v63, v5 offset:1792
    s_waitcnt lgkmcnt(6)
    v_lshl_or_b32 v64, v57, 16, v56
    s_waitcnt lgkmcnt(4)
    v_lshl_or_b32 v65, v59, 16, v58
    s_waitcnt lgkmcnt(2)
    v_lshl_or_b32 v66, v61, 16, v60
    s_waitcnt lgkmcnt(0)
    v_lshl_or_b32 v67, v63, 16, v62
    s_lshl_b32 s26, s26, 10
    v_add_u32 v5, s26, v68
    ds_write_b128 v5, v[64:67] offset:32768
    s_waitcnt lgkmcnt(0)
    s_barrier
    s_cmp_ge_u32 s20, 4
    s_cbranch_scc1 K1G_end
    v_lshlrev_b32 v69, 8, v2
    v_lshl_add_u32 v69, v3, 3, v69
    s_mov_b32 s27, 0xbfb8aa3b
    ds_read_b128 v[104:107], v68 offset:32768
    ds_read_b128 v[108:111], v68 offset:36864
    ds_read_b128 v[112:115], v68 offset:40960
    ds_read_b128 v[116:119], v68 offset:45056
    ds_read_b128 v[120:123], v68 offset:49152
    ds_read_b128 v[124:127], v68 offset:53248
    ds_read_b128 v[128:131], v68 offset:57344
    ds_read_b128 v[132:135], v68 offset:61440
    ds_read_b128 v[136:139], v68 offset:33792
    ds_read_b128 v[140:143], v68 offset:37888
    ds_read_b128 v[144:147], v68 offset:41984
    ds_read_b128 v[148:151], v68 offset:46080
    ds_read_b128 v[152:155], v68 offset:50176
    ds_read_b128 v[156:159], v68 offset:54272
    ds_read_b128 v[160:163], v68 offset:58368
    ds_read_b128 v[164:167], v68 offset:62464
    s_waitcnt lgkmcnt(15)
    v_mfma_f32_32x32x16_bf16 v[72:87], v[104:107], v[24:27], 0
    s_waitcnt lgkmcnt(14)
    v_mfma_f32_32x32x16_bf16 v[72:87], v[108:111], v[28:31], v[72:87]
    s_waitcnt lgkmcnt(13)
    v_mfma_f32_32x32x16_bf16 v[72:87], v[112:115], v[32:35], v[72:87]
    s_waitcnt lgkmcnt(12)
    v_mfma_f32_32x32x16_bf16 v[72:87], v[116:119], v[36:39], v[72:87]
    s_waitcnt lgkmcnt(11)
    v_mfma_f32_32x32x16_bf16 v[72:87], v[120:123], v[40:43], v[72:87]
    s_waitcnt lgkmcnt(10)
    v_mfma_f32_32x32x16_bf16 v[72:87], v[124:127], v[44:47], v[72:87]
    s_waitcnt lgkmcnt(9)
    v_mfma_f32_32x32x16_bf16 v[72:87], v[128:131], v[48:51], v[72:87]
    s_waitcnt lgkmcnt(8)
    v_mfma_f32_32x32x16_bf16 v[72:87], v[132:135], v[52:55], v[72:87]
    ds_read_b128 v[104:107], v68 offset:34816
    ds_read_b128 v[108:111], v68 offset:38912
    ds_read_b128 v[112:115], v68 offset:43008
    ds_read_b128 v[116:119], v68 offset:47104
    ds_read_b128 v[120:123], v68 offset:51200
    ds_read_b128 v[124:127], v68 offset:55296
    ds_read_b128 v[128:131], v68 offset:59392
    ds_read_b128 v[132:135], v68 offset:63488
    s_waitcnt lgkmcnt(15)
    v_mfma_f32_32x32x16_bf16 v[88:103], v[136:139], v[24:27], 0
    s_waitcnt lgkmcnt(14)
    v_mfma_f32_32x32x16_bf16 v[88:103], v[140:143], v[28:31], v[88:103]
    s_waitcnt lgkmcnt(13)
    v_mfma_f32_32x32x16_bf16 v[88:103], v[144:147], v[32:35], v[88:103]
    s_waitcnt lgkmcnt(12)
    v_mfma_f32_32x32x16_bf16 v[88:103], v[148:151], v[36:39], v[88:103]
    s_waitcnt lgkmcnt(11)
    v_mfma_f32_32x32x16_bf16 v[88:103], v[152:155], v[40:43], v[88:103]
    s_waitcnt lgkmcnt(10)
    v_mfma_f32_32x32x16_bf16 v[88:103], v[156:159], v[44:47], v[88:103]
    s_waitcnt lgkmcnt(9)
    v_mfma_f32_32x32x16_bf16 v[88:103], v[160:163], v[48:51], v[88:103]
    s_waitcnt lgkmcnt(8)
    v_mfma_f32_32x32x16_bf16 v[88:103], v[164:167], v[52:55], v[88:103]
    s_add_u32 s28, s25, 0
    v_mul_f32 v72, s27, v72
    v_mul_f32 v73, s27, v73
    v_mul_f32 v74, s27, v74
    v_mul_f32 v75, s27, v75
    v_mul_f32 v76, s27, v76
    v_mul_f32 v77, s27, v77
    v_mul_f32 v78, s27, v78
    v_mul_f32 v79, s27, v79
    v_mul_f32 v80, s27, v80
    v_mul_f32 v81, s27, v81
    v_mul_f32 v82, s27, v82
    v_mul_f32 v83, s27, v83
    v_mul_f32 v84, s27, v84
    v_mul_f32 v85, s27, v85
    v_mul_f32 v86, s27, v86
    v_mul_f32 v87, s27, v87
    v_cvt_pk_bf16_f32 v56, v72, v73
    v_cvt_pk_bf16_f32 v57, v74, v75
    v_cvt_pk_bf16_f32 v58, v76, v77
    v_cvt_pk_bf16_f32 v59, v78, v79
    v_cvt_pk_bf16_f32 v60, v80, v81
    v_cvt_pk_bf16_f32 v61, v82, v83
    v_cvt_pk_bf16_f32 v62, v84, v85
    v_cvt_pk_bf16_f32 v63, v86, v87
    buffer_store_dwordx2 v[56:57], v69, s[16:19], s28 offen offset:0
    buffer_store_dwordx2 v[58:59], v69, s[16:19], s28 offen offset:16
    buffer_store_dwordx2 v[60:61], v69, s[16:19], s28 offen offset:32
    buffer_store_dwordx2 v[62:63], v69, s[16:19], s28 offen offset:48
    ds_read_b128 v[136:139], v68 offset:35840
    ds_read_b128 v[140:143], v68 offset:39936
    ds_read_b128 v[144:147], v68 offset:44032
    ds_read_b128 v[148:151], v68 offset:48128
    ds_read_b128 v[152:155], v68 offset:52224
    ds_read_b128 v[156:159], v68 offset:56320
    ds_read_b128 v[160:163], v68 offset:60416
    ds_read_b128 v[164:167], v68 offset:64512
    s_waitcnt lgkmcnt(15)
    v_mfma_f32_32x32x16_bf16 v[72:87], v[104:107], v[24:27], 0
    s_waitcnt lgkmcnt(14)
    v_mfma_f32_32x32x16_bf16 v[72:87], v[108:111], v[28:31], v[72:87]
    s_waitcnt lgkmcnt(13)
    v_mfma_f32_32x32x16_bf16 v[72:87], v[112:115], v[32:35], v[72:87]
    s_waitcnt lgkmcnt(12)
    v_mfma_f32_32x32x16_bf16 v[72:87], v[116:119], v[36:39], v[72:87]
    s_waitcnt lgkmcnt(11)
    v_mfma_f32_32x32x16_bf16 v[72:87], v[120:123], v[40:43], v[72:87]
    s_waitcnt lgkmcnt(10)
    v_mfma_f32_32x32x16_bf16 v[72:87], v[124:127], v[44:47], v[72:87]
    s_waitcnt lgkmcnt(9)
    v_mfma_f32_32x32x16_bf16 v[72:87], v[128:131], v[48:51], v[72:87]
    s_waitcnt lgkmcnt(8)
    v_mfma_f32_32x32x16_bf16 v[72:87], v[132:135], v[52:55], v[72:87]
    s_add_u32 s28, s25, 64
    v_mul_f32 v88, s27, v88
    v_mul_f32 v89, s27, v89
    v_mul_f32 v90, s27, v90
    v_mul_f32 v91, s27, v91
    v_mul_f32 v92, s27, v92
    v_mul_f32 v93, s27, v93
    v_mul_f32 v94, s27, v94
    v_mul_f32 v95, s27, v95
    v_mul_f32 v96, s27, v96
    v_mul_f32 v97, s27, v97
    v_mul_f32 v98, s27, v98
    v_mul_f32 v99, s27, v99
    v_mul_f32 v100, s27, v100
    v_mul_f32 v101, s27, v101
    v_mul_f32 v102, s27, v102
    v_mul_f32 v103, s27, v103
    v_cvt_pk_bf16_f32 v56, v88, v89
    v_cvt_pk_bf16_f32 v57, v90, v91
    v_cvt_pk_bf16_f32 v58, v92, v93
    v_cvt_pk_bf16_f32 v59, v94, v95
    v_cvt_pk_bf16_f32 v60, v96, v97
    v_cvt_pk_bf16_f32 v61, v98, v99
    v_cvt_pk_bf16_f32 v62, v100, v101
    v_cvt_pk_bf16_f32 v63, v102, v103
    buffer_store_dwordx2 v[56:57], v69, s[16:19], s28 offen offset:0
    buffer_store_dwordx2 v[58:59], v69, s[16:19], s28 offen offset:16
    buffer_store_dwordx2 v[60:61], v69, s[16:19], s28 offen offset:32
    buffer_store_dwordx2 v[62:63], v69, s[16:19], s28 offen offset:48
    s_waitcnt lgkmcnt(7)
    v_mfma_f32_32x32x16_bf16 v[88:103], v[136:139], v[24:27], 0
    s_waitcnt lgkmcnt(6)
    v_mfma_f32_32x32x16_bf16 v[88:103], v[140:143], v[28:31], v[88:103]
    s_waitcnt lgkmcnt(5)
    v_mfma_f32_32x32x16_bf16 v[88:103], v[144:147], v[32:35], v[88:103]
    s_waitcnt lgkmcnt(4)
    v_mfma_f32_32x32x16_bf16 v[88:103], v[148:151], v[36:39], v[88:103]
    s_waitcnt lgkmcnt(3)
    v_mfma_f32_32x32x16_bf16 v[88:103], v[152:155], v[40:43], v[88:103]
    s_waitcnt lgkmcnt(2)
    v_mfma_f32_32x32x16_bf16 v[88:103], v[156:159], v[44:47], v[88:103]
    s_waitcnt lgkmcnt(1)
    v_mfma_f32_32x32x16_bf16 v[88:103], v[160:163], v[48:51], v[88:103]
    s_waitcnt lgkmcnt(0)
    v_mfma_f32_32x32x16_bf16 v[88:103], v[164:167], v[52:55], v[88:103]
    s_add_u32 s28, s25, 128
    v_mul_f32 v72, s27, v72
    v_mul_f32 v73, s27, v73
    v_mul_f32 v74, s27, v74
    v_mul_f32 v75, s27, v75
    v_mul_f32 v76, s27, v76
    v_mul_f32 v77, s27, v77
    v_mul_f32 v78, s27, v78
    v_mul_f32 v79, s27, v79
    v_mul_f32 v80, s27, v80
    v_mul_f32 v81, s27, v81
    v_mul_f32 v82, s27, v82
    v_mul_f32 v83, s27, v83
    v_mul_f32 v84, s27, v84
    v_mul_f32 v85, s27, v85
    v_mul_f32 v86, s27, v86
    v_mul_f32 v87, s27, v87
    v_cvt_pk_bf16_f32 v56, v72, v73
    v_cvt_pk_bf16_f32 v57, v74, v75
    v_cvt_pk_bf16_f32 v58, v76, v77
    v_cvt_pk_bf16_f32 v59, v78, v79
    v_cvt_pk_bf16_f32 v60, v80, v81
    v_cvt_pk_bf16_f32 v61, v82, v83
    v_cvt_pk_bf16_f32 v62, v84, v85
    v_cvt_pk_bf16_f32 v63, v86, v87
    buffer_store_dwordx2 v[56:57], v69, s[16:19], s28 offen offset:0
    buffer_store_dwordx2 v[58:59], v69, s[16:19], s28 offen offset:16
    buffer_store_dwordx2 v[60:61], v69, s[16:19], s28 offen offset:32
    buffer_store_dwordx2 v[62:63], v69, s[16:19], s28 offen offset:48
    s_add_u32 s28, s25, 192
    v_mul_f32 v88, s27, v88
    v_mul_f32 v89, s27, v89
    v_mul_f32 v90, s27, v90
    v_mul_f32 v91, s27, v91
    v_mul_f32 v92, s27, v92
    v_mul_f32 v93, s27, v93
    v_mul_f32 v94, s27, v94
    v_mul_f32 v95, s27, v95
    v_mul_f32 v96, s27, v96
    v_mul_f32 v97, s27, v97
    v_mul_f32 v98, s27, v98
    v_mul_f32 v99, s27, v99
    v_mul_f32 v100, s27, v100
    v_mul_f32 v101, s27, v101
    v_mul_f32 v102, s27, v102
    v_mul_f32 v103, s27, v103
    v_cvt_pk_bf16_f32 v56, v88, v89
    v_cvt_pk_bf16_f32 v57, v90, v91
    v_cvt_pk_bf16_f32 v58, v92, v93
    v_cvt_pk_bf16_f32 v59, v94, v95
    v_cvt_pk_bf16_f32 v60, v96, v97
    v_cvt_pk_bf16_f32 v61, v98, v99
    v_cvt_pk_bf16_f32 v62, v100, v101
    v_cvt_pk_bf16_f32 v63, v102, v103
    buffer_store_dwordx2 v[56:57], v69, s[16:19], s28 offen offset:0
    buffer_store_dwordx2 v[58:59], v69, s[16:19], s28 offen offset:16
    buffer_store_dwordx2 v[60:61], v69, s[16:19], s28 offen offset:32
    buffer_store_dwordx2 v[62:63], v69, s[16:19], s28 offen offset:48
K1G_end:
    s_endpgm
K1_WPREP:
    s_load_dwordx2 s[46:47], s[0:1], 40
    s_load_dwordx2 s[48:49], s[0:1], 56
    s_load_dwordx2 s[52:53], s[0:1], 80
    s_waitcnt lgkmcnt(0)
    s_mov_b32 s8, s46
    s_mov_b32 s9, s47
    s_mov_b32 s10, 0x10500
    s_mov_b32 s11, 0x20000
    s_mov_b32 s12, s48
    s_mov_b32 s13, s49
    s_mov_b32 s14, 0x10000
    s_mov_b32 s15, 0x20000
    s_add_u32 s16, s52, 0xe00000
    s_addc_u32 s17, s53, 0
    s_mov_b32 s18, 0x19000
    s_mov_b32 s19, 0x20000
    v_lshrrev_b32 v1, 6, v0
    s_nop 0
    v_readfirstlane_b32 s20, v1
    v_and_b32 v2, 31, v0
    v_bfe_u32 v3, v0, 5, 1
    v_and_b32 v5, 63, v0
    s_sub_u32 s21, s2, 226
    s_mul_i32 s21, s21, 8
    s_add_u32 s21, s21, s20
    s_cmp_ge_u32 s21, 100
    s_cbranch_scc1 K1W_end
    s_cmp_ge_u32 s21, 96
    s_cbranch_scc1 K1W_ext
    s_lshr_b32 s22, s21, 5
    s_bfe_u32 s23, s21, 0x30002
    s_and_b32 s24, s21, 3
    v_lshlrev_b32 v4, 11, v3
    v_lshl_add_u32 v4, v2, 1, v4
    s_lshl_b32 s25, s23, 12
    s_lshl_b32 s26, s24, 6
    s_add_u32 s25, s25, s26
    s_cmp_eq_u32 s22, 0
    s_cbranch_scc0 K1W_wh
    buffer_load_ushort v8, v4, s[8:11], s25 offen offset:0
    buffer_load_ushort v12, v4, s[8:11], s25 offen offset:256
    buffer_load_ushort v9, v4, s[8:11], s25 offen offset:512
    buffer_load_ushort v13, v4, s[8:11], s25 offen offset:768
    buffer_load_ushort v10, v4, s[8:11], s25 offen offset:1024
    buffer_load_ushort v14, v4, s[8:11], s25 offen offset:1280
    buffer_load_ushort v11, v4, s[8:11], s25 offen offset:1536
    buffer_load_ushort v15, v4, s[8:11], s25 offen offset:1792
    s_waitcnt vmcnt(6)
    v_lshl_or_b32 v8, v12, 16, v8
    s_waitcnt vmcnt(4)
    v_lshl_or_b32 v9, v13, 16, v9
    s_waitcnt vmcnt(2)
    v_lshl_or_b32 v10, v14, 16, v10
    s_waitcnt vmcnt(0)
    v_lshl_or_b32 v11, v15, 16, v11
    s_branch K1W_store
K1W_wh:
    s_sub_u32 s22, s22, 1
    s_lshl_b32 s22, s22, 15
    s_add_u32 s25, s25, s22
    buffer_load_ushort v8, v4, s[12:15], s25 offen offset:0
    buffer_load_ushort v12, v4, s[12:15], s25 offen offset:256
    buffer_load_ushort v9, v4, s[12:15], s25 offen offset:512
    buffer_load_ushort v13, v4, s[12:15], s25 offen offset:768
    buffer_load_ushort v10, v4, s[12:15], s25 offen offset:1024
    buffer_load_ushort v14, v4, s[12:15], s25 offen offset:1280
    buffer_load_ushort v11, v4, s[12:15], s25 offen offset:1536
    buffer_load_ushort v15, v4, s[12:15], s25 offen offset:1792
    s_waitcnt vmcnt(6)
    v_lshl_or_b32 v8, v12, 16, v8
    s_waitcnt vmcnt(4)
    v_lshl_or_b32 v9, v13, 16, v9
    s_waitcnt vmcnt(2)
    v_lshl_or_b32 v10, v14, 16, v10
    s_waitcnt vmcnt(0)
    v_lshl_or_b32 v11, v15, 16, v11
    s_branch K1W_store
K1W_ext:
    s_sub_u32 s24, s21, 96
    s_lshl_b32 s25, s24, 6
    v_lshlrev_b32 v4, 1, v2
    s_add_u32 s26, s25, 65792
    buffer_load_ushort v16, v4, s[8:11], s26 offen
    s_add_u32 s26, s25, 66048
    buffer_load_ushort v17, v4, s[8:11], s26 offen
    s_add_u32 s26, s25, 66304
    buffer_load_ushort v18, v4, s[8:11], s26 offen
    s_add_u32 s26, s25, 66560
    buffer_load_ushort v19, v4, s[8:11], s26 offen
    s_add_u32 s26, s25, 65536
    buffer_load_ushort v20, v4, s[8:11], s26 offen
    s_mov_b32 s27, 0xbfb8aa3b
    v_cmp_eq_u32 s[28:29], 1, v3
    v_mov_b32 v21, 0
    s_waitcnt vmcnt(4)
    v_lshlrev_b32 v16, 16, v16
    v_mul_f32 v16, s27, v16
    s_waitcnt vmcnt(3)
    v_lshlrev_b32 v17, 16, v17
    v_mul_f32 v17, s27, v17
    s_waitcnt vmcnt(2)
    v_lshlrev_b32 v18, 16, v18
    v_mul_f32 v18, s27, v18
    s_waitcnt vmcnt(1)
    v_lshlrev_b32 v19, 16, v19
    v_mul_f32 v19, s27, v19
    s_waitcnt vmcnt(0)
    v_lshlrev_b32 v20, 16, v20
    v_mul_f32 v20, s27, v20
    v_cvt_pk_bf16_f32 v22, v16, v16
    v_lshlrev_b32 v22, 16, v22
    v_sub_f32 v28, v16, v22
    v_cndmask_b32 v16, v16, v28, s[28:29]
    v_cvt_pk_bf16_f32 v23, v17, v17
    v_lshlrev_b32 v23, 16, v23
    v_sub_f32 v29, v17, v23
    v_cndmask_b32 v17, v17, v29, s[28:29]
    v_cvt_pk_bf16_f32 v24, v18, v18
    v_lshlrev_b32 v24, 16, v24
    v_sub_f32 v30, v18, v24
    v_cndmask_b32 v18, v18, v30, s[28:29]
    v_cvt_pk_bf16_f32 v25, v19, v19
    v_lshlrev_b32 v25, 16, v25
    v_sub_f32 v31, v19, v25
    v_cndmask_b32 v19, v19, v31, s[28:29]
    v_cvt_pk_bf16_f32 v26, v20, v20
    v_lshlrev_b32 v26, 16, v26
    v_sub_f32 v32, v20, v26
    v_cndmask_b32 v20, v20, v32, s[28:29]
    v_cvt_pk_bf16_f32 v27, v21, v21
    v_lshlrev_b32 v27, 16, v27
    v_sub_f32 v33, v21, v27
    v_cndmask_b32 v21, v21, v33, s[28:29]
    v_cvt_pk_bf16_f32 v8, v16, v17
    v_cvt_pk_bf16_f32 v9, v18, v19
    v_cvt_pk_bf16_f32 v10, v20, v21
    v_mov_b32 v11, 0
K1W_store:
    v_lshlrev_b32 v4, 4, v5
    s_lshl_b32 s25, s21, 10
    buffer_store_dwordx4 v[8:11], v4, s[16:19], s25 offen
K1W_end:
    s_endpgm
.globl standalone__cheap_equivariant_egnn__graph_kernel
.p2align 8
.type standalone__cheap_equivariant_egnn__graph_kernel,@function
standalone__cheap_equivariant_egnn__graph_kernel:
    s_cmp_ge_u32 s2, 256
    s_cbranch_scc1 K2_EXIT
    s_load_dwordx4 s[76:79], s[0:1], 0
    s_load_dwordx2 s[80:81], s[0:1], 48
    s_load_dwordx2 s[82:83], s[0:1], 64
    s_load_dwordx2 s[84:85], s[0:1], 80
    s_waitcnt lgkmcnt(0)
    s_mov_b32 s8, s76
    s_mov_b32 s9, s77
    s_mov_b32 s10, 0x30d400
    s_mov_b32 s11, 0x20000
    s_mov_b32 s12, s78
    s_mov_b32 s13, s79
    s_mov_b32 s14, 0x124f8
    s_mov_b32 s15, 0x20000
    s_mov_b32 s16, s80
    s_mov_b32 s17, s81
    s_mov_b32 s18, 0x100
    s_mov_b32 s19, 0x20000
    s_mov_b32 s20, s82
    s_mov_b32 s21, s83
    s_mov_b32 s22, 0x31f8f8
    s_mov_b32 s23, 0x20000
    s_mov_b32 s24, s84
    s_mov_b32 s25, s85
    s_mov_b32 s26, 0x61a800
    s_mov_b32 s27, 0x20000
    s_add_u32 s28, s84, 0x640000
    s_addc_u32 s29, s85, 0
    s_mov_b32 s30, 0x186a00
    s_mov_b32 s31, 0x20000
    s_add_u32 s32, s84, 0x800000
    s_addc_u32 s33, s85, 0
    s_mov_b32 s34, 0x100000
    s_mov_b32 s35, 0x20000
    s_add_u32 s36, s84, 0xa00000
    s_addc_u32 s37, s85, 0
    s_mov_b32 s38, 0x30d400
    s_mov_b32 s39, 0x20000
    s_add_u32 s40, s84, 0xe00000
    s_addc_u32 s41, s85, 0
    s_mov_b32 s42, 0x19000
    s_mov_b32 s43, 0x20000
    v_lshrrev_b32 v178, 6, v0
    s_nop 0
    v_readfirstlane_b32 s44, v178
    v_and_b32 v3, 63, v0
    v_and_b32 v1, 31, v0
    v_bfe_u32 v178, v0, 5, 1
    v_lshlrev_b32 v2, 4, v178
    v_lshlrev_b32 v164, 4, v3
    v_lshlrev_b32 v178, 3, v0
    s_lshl_b32 s77, s2, 12
    buffer_load_dwordx2 v[100:101], v178, s[32:35], s77 offen
    s_lshl_b32 s76, s2, 3
    s_mul_i32 s86, s76, 3125
    s_lshr_b32 s86, s86, 9
    s_lshl_b32 s78, s86, 8
    v_lshlrev_b32 v179, 4, v0
    buffer_load_dwordx4 v[52:55], v179, s[8:11], s78 offen
    s_add_u32 s78, s78, 8192
    buffer_load_dwordx4 v[60:63], v179, s[8:11], s78 offen
    s_lshr_b32 s72, s44, 2
    s_and_b32 s73, s44, 3
    s_lshl_b32 s74, s73, 10
    s_lshl_b32 s76, s2, 3
    s_lshl_b32 s77, s72, 2
    s_add_u32 s76, s76, s77
    s_add_u32 s77, s76, 0
    s_mul_i32 s77, s77, 3125
    s_lshr_b32 s78, s77, 9
    s_add_u32 s77, s76, 1
    s_mul_i32 s77, s77, 3125
    s_lshr_b32 s79, s77, 9
    s_add_u32 s77, s76, 2
    s_mul_i32 s77, s77, 3125
    s_lshr_b32 s80, s77, 9
    s_add_u32 s77, s76, 3
    s_mul_i32 s77, s77, 3125
    s_lshr_b32 s81, s77, 9
    s_add_u32 s77, s76, 4
    s_mul_i32 s77, s77, 3125
    s_lshr_b32 s82, s77, 9
    s_mov_b32 s64, s78
    s_sub_u32 s68, s79, s78
    s_mov_b32 s65, s79
    s_sub_u32 s69, s80, s79
    s_mov_b32 s66, s80
    s_sub_u32 s70, s81, s80
    s_mov_b32 s67, s81
    s_sub_u32 s71, s82, s81
    v_lshrrev_b32 v179, 3, v1
    v_add_u32 v179, s76, v179
    v_mul_u32_u24 v177, 0xc35, v179
    v_add_u32 v180, 0xc35, v177
    v_lshrrev_b32 v177, 9, v177
    v_lshrrev_b32 v180, 9, v180
    v_sub_u32 v180, v180, v177
    v_subrev_u32 v180, 1, v180
    v_and_b32 v181, 7, v1
    v_min_u32 v181, v181, v180
    v_add_u32 v181, v181, v177
    v_subrev_u32 v181, s86, v181
    v_mul_u32_u24 v181, 272, v181
    v_add_u32 v181, v181, v2
    v_add_u32 v191, 111872, v181
    s_add_u32 s84, s74, 0
    buffer_load_dwordx4 v[4:7], v164, s[40:43], s84 offen
    s_add_u32 s84, s74, 4096
    buffer_load_dwordx4 v[8:11], v164, s[40:43], s84 offen
    s_add_u32 s84, s74, 8192
    buffer_load_dwordx4 v[12:15], v164, s[40:43], s84 offen
    s_add_u32 s84, s74, 12288
    buffer_load_dwordx4 v[16:19], v164, s[40:43], s84 offen
    s_add_u32 s84, s74, 16384
    buffer_load_dwordx4 v[20:23], v164, s[40:43], s84 offen
    s_add_u32 s84, s74, 20480
    buffer_load_dwordx4 v[24:27], v164, s[40:43], s84 offen
    s_add_u32 s84, s74, 24576
    buffer_load_dwordx4 v[28:31], v164, s[40:43], s84 offen
    s_add_u32 s84, s74, 28672
    buffer_load_dwordx4 v[32:35], v164, s[40:43], s84 offen
    s_mov_b32 s79, 98304
    buffer_load_dwordx4 v[140:143], v164, s[40:43], s79 offen offset:0
    buffer_load_dwordx4 v[144:147], v164, s[40:43], s79 offen offset:1024
    buffer_load_dwordx4 v[148:151], v164, s[40:43], s79 offen offset:2048
    buffer_load_dwordx4 v[152:155], v164, s[40:43], s79 offen offset:3072
    v_lshlrev_b32 v178, 1, v1
    buffer_load_ushort v160, v178, s[16:19], 0 offen offset:0
    buffer_load_ushort v161, v178, s[16:19], 0 offen offset:64
    buffer_load_ushort v162, v178, s[16:19], 0 offen offset:128
    buffer_load_ushort v163, v178, s[16:19], 0 offen offset:192
    s_mov_b32 s56, 0
    s_mov_b32 s57, -1
    s_mov_b32 s87, 0xffffff00
    s_mov_b32 s88, 0xe0
    s_mov_b32 s89, 0xffff0000
    v_mov_b32 v165, 0x3f80
    s_mul_i32 s54, s44, 7808
    s_add_u32 s54, s54, 256
    v_lshlrev_b32 v178, 4, v1
    v_add_u32 v189, s54, v178
    s_add_u32 s76, s54, 4608
    v_lshlrev_b32 v178, 2, v1
    v_add_u32 v190, s76, v178
    s_add_u32 s55, s54, 5760
    v_add_u32 v176, s55, v164
    v_lshrrev_b32 v178, 4, v1
    v_lshlrev_b32 v166, 10, v178
    v_bfe_u32 v178, v1, 2, 1
    v_lshl_add_u32 v166, v178, 9, v166
    v_bfe_u32 v178, v1, 3, 1
    v_and_b32 v179, 3, v1
    v_lshl_add_u32 v178, v178, 2, v179
    v_lshl_add_u32 v166, v178, 1, v166
    v_add_u32 v166, s55, v166
    v_lshrrev_b32 v178, 3, v1
    v_bfe_u32 v179, v0, 5, 1
    v_and_b32 v177, 1, v1
    v_cmp_eq_u32 vcc, 1, v177
    v_mov_b32 v177, 0x3f80
    v_mov_b32 v180, 0x3f800000
    v_cndmask_b32 v177, v177, v180, vcc
    v_cmp_eq_u32 vcc, v178, v179
    s_nop 1
    v_cndmask_b32 v180, 0, v177, vcc
    v_add_u32 v179, 2, v179
    v_cmp_eq_u32 vcc, v178, v179
    s_nop 1
    v_cndmask_b32 v181, 0, v177, vcc
    v_bfe_u32 v178, v1, 1, 2
    v_cmp_eq_u32 vcc, 0, v178
    s_nop 1
    v_cndmask_b32 v116, 0, v180, vcc
    v_cndmask_b32 v120, 0, v181, vcc
    v_cmp_eq_u32 vcc, 1, v178
    s_nop 1
    v_cndmask_b32 v117, 0, v180, vcc
    v_cndmask_b32 v121, 0, v181, vcc
    v_cmp_eq_u32 vcc, 2, v178
    s_nop 1
    v_cndmask_b32 v118, 0, v180, vcc
    v_cndmask_b32 v122, 0, v181, vcc
    v_cmp_eq_u32 vcc, 3, v178
    s_nop 1
    v_cndmask_b32 v119, 0, v180, vcc
    v_cndmask_b32 v123, 0, v181, vcc
    v_mov_b32 v156, 0
    v_mov_b32 v157, 0
    v_mov_b32 v158, 0
    v_mov_b32 v159, 0
    s_nop 1
    v_mfma_f32_32x32x16_bf16 a[0:15], v[156:159], v[156:159], 0
    v_mfma_f32_32x32x16_bf16 a[16:31], v[156:159], v[156:159], 0
    v_mfma_f32_32x32x16_bf16 a[32:47], v[156:159], v[156:159], 0
    v_mfma_f32_32x32x16_bf16 a[48:63], v[156:159], v[156:159], 0
    v_and_b32 v178, 15, v3
    v_lshrrev_b32 v179, 1, v178
    v_and_b32 v177, 1, v178
    v_lshlrev_b32 v177, 2, v177
    v_sub_u32 v179, v179, v177
    v_lshlrev_b32 v177, 4, v179
    v_mov_b32 v112, 0x3f80
    v_mov_b32 v113, 0
    v_lshlrev_b64 v[108:109], v177, v[112:113]
    v_cmp_gt_u32 vcc, 4, v179
    s_nop 1
    v_cndmask_b32 v108, 0, v108, vcc
    v_cndmask_b32 v109, 0, v109, vcc
    v_mov_b32 v110, v108
    v_mov_b32 v111, v109
    v_lshlrev_b32 v178, 4, v178
    ds_write_b128 v178, v[108:111]
    v_lshlrev_b32 v178, 3, v0
    v_add_u32 v178, 129280, v178
    s_waitcnt vmcnt(18)
    ds_write_b64 v178, v[100:101]
    v_lshrrev_b32 v178, 4, v0
    v_mul_u32_u24 v178, 272, v178
    v_and_b32 v179, 15, v0
    v_lshl_add_u32 v178, v179, 4, v178
    v_add_u32 v178, 111872, v178
    s_waitcnt vmcnt(17)
    ds_write_b128 v178, v[52:55]
    s_waitcnt vmcnt(16)
    ds_write_b128 v178, v[60:63] offset:8704
    s_waitcnt lgkmcnt(0)
    s_barrier
    ds_read_b128 v[68:71], v191 offset:0
    ds_read_b128 v[72:75], v191 offset:32
    ds_read_b128 v[76:79], v191 offset:64
    ds_read_b128 v[80:83], v191 offset:96
    ds_read_b128 v[84:87], v191 offset:128
    ds_read_b128 v[88:91], v191 offset:160
    ds_read_b128 v[92:95], v191 offset:192
    ds_read_b128 v[96:99], v191 offset:224
    v_lshlrev_b32 v178, 5, v3
    v_add_u32 v178, 129280, v178
    ds_read_b128 v[36:39], v178
    ds_read_b128 v[40:43], v178 offset:16
    ds_read_b128 v[44:47], v178 offset:2048
    ds_read_b128 v[48:51], v178 offset:2064
    s_waitcnt lgkmcnt(3)
    v_lshrrev_b32 v36, 16, v36
    s_waitcnt lgkmcnt(1)
    v_lshrrev_b32 v44, 16, v44
    v_add_u32 v36, v36, v44
    v_lshrrev_b32 v37, 16, v37
    v_lshrrev_b32 v45, 16, v45
    v_add_u32 v37, v37, v45
    v_lshrrev_b32 v38, 16, v38
    v_lshrrev_b32 v46, 16, v46
    v_add_u32 v38, v38, v46
    v_lshrrev_b32 v39, 16, v39
    v_lshrrev_b32 v47, 16, v47
    v_add_u32 v39, v39, v47
    v_lshrrev_b32 v40, 16, v40
    s_waitcnt lgkmcnt(0)
    v_lshrrev_b32 v48, 16, v48
    v_add_u32 v40, v40, v48
    v_lshrrev_b32 v41, 16, v41
    v_lshrrev_b32 v49, 16, v49
    v_add_u32 v41, v41, v49
    v_lshrrev_b32 v42, 16, v42
    v_lshrrev_b32 v50, 16, v50
    v_add_u32 v42, v42, v50
    v_lshrrev_b32 v43, 16, v43
    v_lshrrev_b32 v51, 16, v51
    v_add_u32 v43, v43, v51
    v_add_u32_dpp v36, v36, v36 row_shr:1 row_mask:0xf bank_mask:0xf bound_ctrl:0
    v_add_u32_dpp v37, v37, v37 row_shr:1 row_mask:0xf bank_mask:0xf bound_ctrl:0
    v_add_u32_dpp v38, v38, v38 row_shr:1 row_mask:0xf bank_mask:0xf bound_ctrl:0
    v_add_u32_dpp v39, v39, v39 row_shr:1 row_mask:0xf bank_mask:0xf bound_ctrl:0
    v_add_u32_dpp v40, v40, v40 row_shr:1 row_mask:0xf bank_mask:0xf bound_ctrl:0
    v_add_u32_dpp v41, v41, v41 row_shr:1 row_mask:0xf bank_mask:0xf bound_ctrl:0
    v_add_u32_dpp v42, v42, v42 row_shr:1 row_mask:0xf bank_mask:0xf bound_ctrl:0
    v_add_u32_dpp v43, v43, v43 row_shr:1 row_mask:0xf bank_mask:0xf bound_ctrl:0
    v_add_u32_dpp v36, v36, v36 row_shr:2 row_mask:0xf bank_mask:0xf bound_ctrl:0
    v_add_u32_dpp v37, v37, v37 row_shr:2 row_mask:0xf bank_mask:0xf bound_ctrl:0
    v_add_u32_dpp v38, v38, v38 row_shr:2 row_mask:0xf bank_mask:0xf bound_ctrl:0
    v_add_u32_dpp v39, v39, v39 row_shr:2 row_mask:0xf bank_mask:0xf bound_ctrl:0
    v_add_u32_dpp v40, v40, v40 row_shr:2 row_mask:0xf bank_mask:0xf bound_ctrl:0
    v_add_u32_dpp v41, v41, v41 row_shr:2 row_mask:0xf bank_mask:0xf bound_ctrl:0
    v_add_u32_dpp v42, v42, v42 row_shr:2 row_mask:0xf bank_mask:0xf bound_ctrl:0
    v_add_u32_dpp v43, v43, v43 row_shr:2 row_mask:0xf bank_mask:0xf bound_ctrl:0
    v_add_u32_dpp v36, v36, v36 row_shr:4 row_mask:0xf bank_mask:0xf bound_ctrl:0
    v_add_u32_dpp v37, v37, v37 row_shr:4 row_mask:0xf bank_mask:0xf bound_ctrl:0
    v_add_u32_dpp v38, v38, v38 row_shr:4 row_mask:0xf bank_mask:0xf bound_ctrl:0
    v_add_u32_dpp v39, v39, v39 row_shr:4 row_mask:0xf bank_mask:0xf bound_ctrl:0
    v_add_u32_dpp v40, v40, v40 row_shr:4 row_mask:0xf bank_mask:0xf bound_ctrl:0
    v_add_u32_dpp v41, v41, v41 row_shr:4 row_mask:0xf bank_mask:0xf bound_ctrl:0
    v_add_u32_dpp v42, v42, v42 row_shr:4 row_mask:0xf bank_mask:0xf bound_ctrl:0
    v_add_u32_dpp v43, v43, v43 row_shr:4 row_mask:0xf bank_mask:0xf bound_ctrl:0
    v_add_u32_dpp v36, v36, v36 row_shr:8 row_mask:0xf bank_mask:0xf bound_ctrl:0
    v_add_u32_dpp v37, v37, v37 row_shr:8 row_mask:0xf bank_mask:0xf bound_ctrl:0
    v_add_u32_dpp v38, v38, v38 row_shr:8 row_mask:0xf bank_mask:0xf bound_ctrl:0
    v_add_u32_dpp v39, v39, v39 row_shr:8 row_mask:0xf bank_mask:0xf bound_ctrl:0
    v_add_u32_dpp v40, v40, v40 row_shr:8 row_mask:0xf bank_mask:0xf bound_ctrl:0
    v_add_u32_dpp v41, v41, v41 row_shr:8 row_mask:0xf bank_mask:0xf bound_ctrl:0
    v_add_u32_dpp v42, v42, v42 row_shr:8 row_mask:0xf bank_mask:0xf bound_ctrl:0
    v_add_u32_dpp v43, v43, v43 row_shr:8 row_mask:0xf bank_mask:0xf bound_ctrl:0
    v_add_u32_dpp v36, v36, v36 row_bcast:15 row_mask:0xa bank_mask:0xf
    v_add_u32_dpp v37, v37, v37 row_bcast:15 row_mask:0xa bank_mask:0xf
    v_add_u32_dpp v38, v38, v38 row_bcast:15 row_mask:0xa bank_mask:0xf
    v_add_u32_dpp v39, v39, v39 row_bcast:15 row_mask:0xa bank_mask:0xf
    v_add_u32_dpp v40, v40, v40 row_bcast:15 row_mask:0xa bank_mask:0xf
    v_add_u32_dpp v41, v41, v41 row_bcast:15 row_mask:0xa bank_mask:0xf
    v_add_u32_dpp v42, v42, v42 row_bcast:15 row_mask:0xa bank_mask:0xf
    v_add_u32_dpp v43, v43, v43 row_bcast:15 row_mask:0xa bank_mask:0xf
    v_add_u32_dpp v36, v36, v36 row_bcast:31 row_mask:0xc bank_mask:0xf
    v_add_u32_dpp v37, v37, v37 row_bcast:31 row_mask:0xc bank_mask:0xf
    v_add_u32_dpp v38, v38, v38 row_bcast:31 row_mask:0xc bank_mask:0xf
    v_add_u32_dpp v39, v39, v39 row_bcast:31 row_mask:0xc bank_mask:0xf
    v_add_u32_dpp v40, v40, v40 row_bcast:31 row_mask:0xc bank_mask:0xf
    v_add_u32_dpp v41, v41, v41 row_bcast:31 row_mask:0xc bank_mask:0xf
    v_add_u32_dpp v42, v42, v42 row_bcast:31 row_mask:0xc bank_mask:0xf
    v_add_u32_dpp v43, v43, v43 row_bcast:31 row_mask:0xc bank_mask:0xf
    v_readlane_b32 s76, v36, 63
    v_readlane_b32 s77, v37, 63
    v_readlane_b32 s78, v38, 63
    v_readlane_b32 s79, v39, 63
    v_readlane_b32 s80, v40, 63
    v_readlane_b32 s81, v41, 63
    v_readlane_b32 s82, v42, 63
    v_readlane_b32 s83, v43, 63
    s_lshl_b32 s76, s76, 3
    s_or_b32 s76, s76, 7
    s_lshl_b32 s77, s77, 3
    s_or_b32 s77, s77, 6
    s_lshl_b32 s78, s78, 3
    s_or_b32 s78, s78, 5
    s_lshl_b32 s79, s79, 3
    s_or_b32 s79, s79, 4
    s_lshl_b32 s80, s80, 3
    s_or_b32 s80, s80, 3
    s_lshl_b32 s81, s81, 3
    s_or_b32 s81, s81, 2
    s_lshl_b32 s82, s82, 3
    s_or_b32 s82, s82, 1
    s_lshl_b32 s83, s83, 3
    s_or_b32 s83, s83, 0
    v_mov_b32 v179, 0
    v_cmp_eq_u32 vcc, 0, v3
    v_mov_b32 v177, s76
    s_nop 0
    v_cndmask_b32 v179, v179, v177, vcc
    v_cmp_eq_u32 vcc, 1, v3
    v_mov_b32 v177, s77
    s_nop 0
    v_cndmask_b32 v179, v179, v177, vcc
    v_cmp_eq_u32 vcc, 2, v3
    v_mov_b32 v177, s78
    s_nop 0
    v_cndmask_b32 v179, v179, v177, vcc
    v_cmp_eq_u32 vcc, 3, v3
    v_mov_b32 v177, s79
    s_nop 0
    v_cndmask_b32 v179, v179, v177, vcc
    v_cmp_eq_u32 vcc, 4, v3
    v_mov_b32 v177, s80
    s_nop 0
    v_cndmask_b32 v179, v179, v177, vcc
    v_cmp_eq_u32 vcc, 5, v3
    v_mov_b32 v177, s81
    s_nop 0
    v_cndmask_b32 v179, v179, v177, vcc
    v_cmp_eq_u32 vcc, 6, v3
    v_mov_b32 v177, s82
    s_nop 0
    v_cndmask_b32 v179, v179, v177, vcc
    v_cmp_eq_u32 vcc, 7, v3
    v_mov_b32 v177, s83
    s_nop 0
    v_cndmask_b32 v179, v179, v177, vcc
    v_mov_b32 v180, 0
    v_cmp_lt_u32 vcc, v179, s76
    s_nop 1
    v_addc_co_u32 v180, vcc, 0, v180, vcc
    v_cmp_lt_u32 vcc, v179, s77
    s_nop 1
    v_addc_co_u32 v180, vcc, 0, v180, vcc
    v_cmp_lt_u32 vcc, v179, s78
    s_nop 1
    v_addc_co_u32 v180, vcc, 0, v180, vcc
    v_cmp_lt_u32 vcc, v179, s79
    s_nop 1
    v_addc_co_u32 v180, vcc, 0, v180, vcc
    v_cmp_lt_u32 vcc, v179, s80
    s_nop 1
    v_addc_co_u32 v180, vcc, 0, v180, vcc
    v_cmp_lt_u32 vcc, v179, s81
    s_nop 1
    v_addc_co_u32 v180, vcc, 0, v180, vcc
    v_cmp_lt_u32 vcc, v179, s82
    s_nop 1
    v_addc_co_u32 v180, vcc, 0, v180, vcc
    v_cmp_lt_u32 vcc, v179, s83
    s_nop 1
    v_addc_co_u32 v180, vcc, 0, v180, vcc
    s_sub_u32 s58, 11, s44
    s_cmp_lt_u32 s44, 4
    s_cselect_b32 s58, s44, s58
    v_cmp_eq_u32 vcc, s58, v180
    v_cmp_gt_u32 s[60:61], 8, v3
    s_and_b64 s[60:61], s[60:61], vcc
    s_ff1_i32_b64 s75, s[60:61]
    s_lshl_b32 s45, s2, 3
    s_add_u32 s45, s45, s75
    s_mul_i32 s46, s45, 3125
    s_add_u32 s76, s46, 3125
    s_lshr_b32 s46, s46, 9
    s_lshr_b32 s76, s76, 9
    s_sub_u32 s47, s76, s46
    v_lshlrev_b32 v178, 6, v3
    s_lshl_b32 s76, s75, 2
    v_add_u32 v178, s76, v178
    v_add_u32 v178, 129280, v178
    ds_read_b32 v183, v178
    ds_read_b32 v184, v178 offset:32
    s_waitcnt lgkmcnt(1)
    v_lshrrev_b32 v178, 16, v183
    s_waitcnt lgkmcnt(0)
    v_lshrrev_b32 v179, 16, v184
    v_add_u32 v177, v178, v179
    v_mov_b32 v180, v177
    s_nop 1
    v_add_u32_dpp v180, v180, v180 row_shr:1 row_mask:0xf bank_mask:0xf bound_ctrl:0
    s_nop 1
    v_add_u32_dpp v180, v180, v180 row_shr:2 row_mask:0xf bank_mask:0xf bound_ctrl:0
    s_nop 1
    v_add_u32_dpp v180, v180, v180 row_shr:4 row_mask:0xf bank_mask:0xf bound_ctrl:0
    s_nop 1
    v_add_u32_dpp v180, v180, v180 row_shr:8 row_mask:0xf bank_mask:0xf bound_ctrl:0
    s_nop 1
    v_add_u32_dpp v180, v180, v180 row_bcast:15 row_mask:0xa bank_mask:0xf
    s_nop 1
    v_add_u32_dpp v180, v180, v180 row_bcast:31 row_mask:0xc bank_mask:0xf
    s_nop 0
    v_readlane_b32 s48, v180, 63
    v_sub_u32 v185, v180, v177
    v_add_u32 v186, v185, v178
    v_mul_u32_u24 v180, 0x186a, v3
    v_and_b32 v187, 0xffff, v183
    v_and_b32 v188, 0xffff, v184
    v_add_u32 v187, v187, v180
    v_add_u32 v180, 3125, v180
    v_add_u32 v188, v188, v180
    v_lshrrev_b32 v183, 16, v183
    v_lshrrev_b32 v184, 16, v184
    s_waitcnt vmcnt(3)
    v_lshlrev_b32 v160, 16, v160
    s_waitcnt vmcnt(2)
    v_lshlrev_b32 v161, 16, v161
    s_waitcnt vmcnt(1)
    v_lshlrev_b32 v162, 16, v162
    s_waitcnt vmcnt(0)
    v_lshlrev_b32 v163, 16, v163
    s_mov_b32 s49, 0
K2_WIN:
    s_sub_u32 s50, s48, s49
    s_min_u32 s50, s50, 288
    v_subrev_u32 v181, s49, v185
    v_sub_u32 v178, 0, v181
    v_max_i32 v178, 0, v178
    v_sub_u32 v179, 288, v181
    v_min_i32 v179, v179, v183
    v_subrev_u32 v181, s49, v186
    v_sub_u32 v177, 0, v181
    v_max_i32 v177, 0, v177
    v_sub_u32 v180, 288, v181
    v_min_i32 v180, v180, v184
    v_subrev_u32 v181, s49, v185
    v_add_u32 v181, v181, v178
    v_lshl_add_u32 v36, v181, 2, s55
    v_subrev_u32 v181, s49, v186
    v_add_u32 v181, v181, v177
    v_lshl_add_u32 v37, v181, 2, s55
    v_add_u32 v38, v187, v178
    v_add_u32 v39, v188, v177
K2_LIST:
    v_cmp_lt_i32 s[58:59], v178, v179
    v_cmp_lt_i32 s[60:61], v177, v180
    s_or_b64 s[62:63], s[58:59], s[60:61]
    s_cbranch_scc0 K2_LISTDONE
    s_mov_b64 exec, s[58:59]
    ds_write_b32 v36, v38
    s_mov_b64 exec, s[60:61]
    ds_write_b32 v37, v39
    s_mov_b64 exec, -1
    v_add_u32 v178, 1, v178
    v_add_u32 v177, 1, v177
    v_add_u32 v38, 1, v38
    v_add_u32 v39, 1, v39
    v_add_u32 v36, 4, v36
    v_add_u32 v37, 4, v37
    s_branch K2_LIST
K2_LISTDONE:
    v_lshl_add_u32 v181, v3, 2, s55
    ds_read_b32 v40, v181 offset:0
    ds_read_b32 v41, v181 offset:256
    ds_read_b32 v42, v181 offset:512
    ds_read_b32 v43, v181 offset:768
    ds_read_b32 v44, v181 offset:1024
    v_mov_b32 v182, 0x0fffffff
    v_add_u32 v178, 0, v3
    v_cmp_gt_u32 vcc, s50, v178
    s_waitcnt lgkmcnt(4)
    s_nop 0
    v_cndmask_b32 v40, v182, v40, vcc
    v_lshlrev_b32 v45, 2, v40
    v_lshlrev_b32 v40, 4, v40
    v_add_u32 v178, 64, v3
    v_cmp_gt_u32 vcc, s50, v178
    s_waitcnt lgkmcnt(3)
    s_nop 0
    v_cndmask_b32 v41, v182, v41, vcc
    v_lshlrev_b32 v46, 2, v41
    v_lshlrev_b32 v41, 4, v41
    v_add_u32 v178, 128, v3
    v_cmp_gt_u32 vcc, s50, v178
    s_waitcnt lgkmcnt(2)
    s_nop 0
    v_cndmask_b32 v42, v182, v42, vcc
    v_lshlrev_b32 v47, 2, v42
    v_lshlrev_b32 v42, 4, v42
    v_add_u32 v178, 192, v3
    v_cmp_gt_u32 vcc, s50, v178
    s_waitcnt lgkmcnt(1)
    s_nop 0
    v_cndmask_b32 v43, v182, v43, vcc
    v_lshlrev_b32 v48, 2, v43
    v_lshlrev_b32 v43, 4, v43
    v_add_u32 v178, 256, v3
    v_cmp_gt_u32 vcc, s50, v178
    s_waitcnt lgkmcnt(0)
    s_nop 0
    v_cndmask_b32 v44, v182, v44, vcc
    v_lshlrev_b32 v49, 2, v44
    v_lshlrev_b32 v44, 4, v44
    buffer_load_dwordx4 v[124:127], v40, s[24:27], 0 offen
    buffer_load_dword v56, v45, s[28:31], 0 offen
    buffer_load_dwordx4 v[128:131], v41, s[24:27], 0 offen
    buffer_load_dword v57, v46, s[28:31], 0 offen
    buffer_load_dwordx4 v[132:135], v42, s[24:27], 0 offen
    buffer_load_dword v58, v47, s[28:31], 0 offen
    buffer_load_dwordx4 v[136:139], v43, s[24:27], 0 offen
    buffer_load_dword v59, v48, s[28:31], 0 offen
    s_cmp_le_u32 s50, 256
    s_cbranch_scc1 K2_SK4A
    buffer_load_dwordx4 v[52:55], v44, s[24:27], 0 offen
    buffer_load_dword v60, v49, s[28:31], 0 offen
K2_SK4A:
    s_cmp_lg_u32 s49, 0
    s_cbranch_scc1 K2_NOP1
    v_mfma_f32_32x32x16_bf16 v[36:51], v[68:71], v[4:7], 0
    v_mfma_f32_32x32x16_bf16 v[36:51], v[72:75], v[8:11], v[36:51]
    s_waitcnt vmcnt(13)
    v_mfma_f32_32x32x16_bf16 v[36:51], v[76:79], v[12:15], v[36:51]
    s_waitcnt vmcnt(12)
    v_mfma_f32_32x32x16_bf16 v[36:51], v[80:83], v[16:19], v[36:51]
    s_waitcnt vmcnt(11)
    v_mfma_f32_32x32x16_bf16 v[36:51], v[84:87], v[20:23], v[36:51]
    s_waitcnt vmcnt(10)
    v_mfma_f32_32x32x16_bf16 v[36:51], v[88:91], v[24:27], v[36:51]
    s_waitcnt vmcnt(9)
    v_mfma_f32_32x32x16_bf16 v[36:51], v[92:95], v[28:31], v[36:51]
    s_waitcnt vmcnt(8)
    v_mfma_f32_32x32x16_bf16 v[36:51], v[96:99], v[32:35], v[36:51]
    s_mov_b32 s76, 0xbfb8aa3b
    s_lshl_b32 s77, s72, 14
    s_add_u32 s77, s77, s74
    s_add_u32 s77, s77, 62720
    v_add_u32 v182, s77, v164
    s_nop 6
    v_mul_f32 v36, s76, v36
    v_mul_f32 v37, s76, v37
    v_mul_f32 v38, s76, v38
    v_mul_f32 v39, s76, v39
    v_mul_f32 v40, s76, v40
    v_mul_f32 v41, s76, v41
    v_mul_f32 v42, s76, v42
    v_mul_f32 v43, s76, v43
    v_mul_f32 v44, s76, v44
    v_mul_f32 v45, s76, v45
    v_mul_f32 v46, s76, v46
    v_mul_f32 v47, s76, v47
    v_mul_f32 v48, s76, v48
    v_mul_f32 v49, s76, v49
    v_mul_f32 v50, s76, v50
    v_mul_f32 v51, s76, v51
    v_cvt_pk_bf16_f32 v108, v36, v37
    v_cvt_pk_bf16_f32 v109, v38, v39
    v_lshlrev_b32 v178, 16, v108
    v_and_b32 v179, s89, v108
    v_lshlrev_b32 v177, 16, v109
    v_and_b32 v180, s89, v109
    v_sub_f32 v178, v36, v178
    v_sub_f32 v179, v37, v179
    v_sub_f32 v177, v38, v177
    v_sub_f32 v180, v39, v180
    v_cvt_pk_bf16_f32 v110, v178, v179
    v_cvt_pk_bf16_f32 v111, v177, v180
    ds_write_b128 v182, v[108:111] offset:0
    v_cvt_pk_bf16_f32 v112, v40, v41
    v_cvt_pk_bf16_f32 v113, v42, v43
    v_lshlrev_b32 v178, 16, v112
    v_and_b32 v179, s89, v112
    v_lshlrev_b32 v177, 16, v113
    v_and_b32 v180, s89, v113
    v_sub_f32 v178, v40, v178
    v_sub_f32 v179, v41, v179
    v_sub_f32 v177, v42, v177
    v_sub_f32 v180, v43, v180
    v_cvt_pk_bf16_f32 v114, v178, v179
    v_cvt_pk_bf16_f32 v115, v177, v180
    ds_write_b128 v182, v[112:115] offset:4096
    v_cvt_pk_bf16_f32 v108, v44, v45
    v_cvt_pk_bf16_f32 v109, v46, v47
    v_lshlrev_b32 v178, 16, v108
    v_and_b32 v179, s89, v108
    v_lshlrev_b32 v177, 16, v109
    v_and_b32 v180, s89, v109
    v_sub_f32 v178, v44, v178
    v_sub_f32 v179, v45, v179
    v_sub_f32 v177, v46, v177
    v_sub_f32 v180, v47, v180
    v_cvt_pk_bf16_f32 v110, v178, v179
    v_cvt_pk_bf16_f32 v111, v177, v180
    ds_write_b128 v182, v[108:111] offset:8192
    v_cvt_pk_bf16_f32 v112, v48, v49
    v_cvt_pk_bf16_f32 v113, v50, v51
    v_lshlrev_b32 v178, 16, v112
    v_and_b32 v179, s89, v112
    v_lshlrev_b32 v177, 16, v113
    v_and_b32 v180, s89, v113
    v_sub_f32 v178, v48, v178
    v_sub_f32 v179, v49, v179
    v_sub_f32 v177, v50, v177
    v_sub_f32 v180, v51, v180
    v_cvt_pk_bf16_f32 v114, v178, v179
    v_cvt_pk_bf16_f32 v115, v177, v180
    ds_write_b128 v182, v[112:115] offset:12288
    s_waitcnt lgkmcnt(0)
    s_barrier
K2_NOP1:
    v_lshlrev_b32 v178, 4, v3
    v_add_u32 v178, s54, v178
    s_add_u32 s76, s54, 4608
    v_lshlrev_b32 v179, 2, v3
    v_add_u32 v179, s76, v179
    s_waitcnt vmcnt(7)
    ds_write_b128 v178, v[124:127] offset:0
    s_waitcnt vmcnt(6)
    ds_write_b32 v179, v56 offset:0
    s_waitcnt vmcnt(5)
    ds_write_b128 v178, v[128:131] offset:1024
    s_waitcnt vmcnt(4)
    ds_write_b32 v179, v57 offset:256
    s_waitcnt vmcnt(3)
    ds_write_b128 v178, v[132:135] offset:2048
    s_waitcnt vmcnt(2)
    ds_write_b32 v179, v58 offset:512
    s_waitcnt vmcnt(1)
    ds_write_b128 v178, v[136:139] offset:3072
    s_waitcnt vmcnt(0)
    ds_write_b32 v179, v59 offset:768
    s_cmp_le_u32 s50, 256
    s_cbranch_scc1 K2_SK4B
    s_mov_b32 exec_hi, 0
    ds_write_b128 v178, v[52:55] offset:4096
    ds_write_b32 v179, v60 offset:1024
K2_SK4B:
    s_mov_b64 exec, -1
    s_lshl_b32 s76, s75, 12
    s_add_u32 s76, s76, 62720
    v_add_u32 v177, s76, v164
    ds_read_b128 v[124:127], v177 offset:0
    ds_read_b128 v[128:131], v177 offset:1024
    ds_read_b128 v[132:135], v177 offset:2048
    ds_read_b128 v[136:139], v177 offset:3072
    v_mov_b32 v52, 0
    v_mov_b32 v60, 0
    v_mov_b32 v53, 0
    v_mov_b32 v61, 0
    v_mov_b32 v54, 0
    v_mov_b32 v62, 0
    v_mov_b32 v55, 0
    v_mov_b32 v63, 0
    v_mov_b32 v56, 0
    v_mov_b32 v64, 0
    v_mov_b32 v57, 0
    v_mov_b32 v65, 0
    v_mov_b32 v58, 0
    v_mov_b32 v66, 0
    v_mov_b32 v59, 0
    v_mov_b32 v67, 0
    s_lshr_b32 s51, s50, 5
    s_and_b32 s52, s50, 31
    s_lshl_b32 s53, s50, 4
    s_add_u32 s53, s53, s54
    s_add_u32 s53, s53, 512
    v_mov_b32 v167, v189
    ds_read_b32 v171, v190
    ds_read_b32 v172, v190 offset:128
    ds_read_b128 v[104:107], v167
    s_waitcnt lgkmcnt(2)
    v_and_or_b32 v169, v171, s87, v2
    buffer_load_dwordx4 v[68:71], v169, s[36:39], 0 offen offset:0
    buffer_load_dwordx4 v[72:75], v169, s[36:39], 0 offen offset:32
    buffer_load_dwordx4 v[76:79], v169, s[36:39], 0 offen offset:64
    buffer_load_dwordx4 v[80:83], v169, s[36:39], 0 offen offset:96
    buffer_load_dwordx4 v[84:87], v169, s[36:39], 0 offen offset:128
    buffer_load_dwordx4 v[88:91], v169, s[36:39], 0 offen offset:160
    buffer_load_dwordx4 v[92:95], v169, s[36:39], 0 offen offset:192
    buffer_load_dwordx4 v[96:99], v169, s[36:39], 0 offen offset:224
    v_and_or_b32 v173, v171, s88, v2
    ds_read_b128 v[100:103], v173
    v_mov_b32 v108, 0
    v_mov_b32 v109, 0
    v_mov_b32 v110, 0
    v_mov_b32 v111, 0
    v_mov_b32 v112, 0
    v_mov_b32 v113, 0
    v_mov_b32 v114, 0
    v_mov_b32 v115, 0
    v_add_u32 v167, 512, v167
    ds_write_b128 v176, v[156:159]
    ds_write_b128 v176, v[156:159] offset:1024
    v_lshl_add_u32 v174, v173, 1, v166
    s_waitcnt lgkmcnt(3)
    v_and_or_b32 v175, v106, s89, v165
    v_cndmask_b32 v175, v175, v107, s[56:57]
    v_cmp_gt_u32 vcc, s53, v167
    s_nop 1
    v_cndmask_b32 v175, 0, v175, vcc
    ds_write_b16 v174, v175
    ds_write_b16_d16_hi v174, v175 offset:16
    v_mov_b32 v171, v172
    v_and_or_b32 v169, v171, s87, v2
    v_add_u32 v168, 256, v190
    s_waitcnt vmcnt(7)
    v_mfma_f32_32x32x16_bf16 v[4:19], v[68:71], v[116:119], 0
    s_waitcnt vmcnt(6)
    v_mfma_f32_32x32x16_bf16 v[4:19], v[72:75], v[120:123], v[4:19]
    s_waitcnt lgkmcnt(4)
    v_mfma_f32_32x32x16_bf16 v[4:19], v[100:103], v[124:127], v[4:19]
    v_mfma_f32_32x32x16_bf16 v[4:19], v[104:107], v[140:143], v[4:19]
    s_cmp_eq_u32 s51, 0
    s_cbranch_scc1 K2_TAILCHK
    s_mov_b32 s76, s51
K2_LOOP:
    s_waitcnt vmcnt(5)
    v_mfma_f32_32x32x16_bf16 v[20:35], v[76:79], v[116:119], 0
    s_nop 6
    v_exp_f32 v36, v4
    v_exp_f32 v37, v5
    v_exp_f32 v38, v6
    v_exp_f32 v39, v7
    s_waitcnt vmcnt(4)
    v_mfma_f32_32x32x16_bf16 v[20:35], v[80:83], v[120:123], v[20:35]
    v_exp_f32 v40, v8
    v_exp_f32 v41, v9
    buffer_load_dwordx4 v[68:71], v169, s[36:39], 0 offen offset:0
    buffer_load_dwordx4 v[72:75], v169, s[36:39], 0 offen offset:32
    buffer_load_dwordx4 v[76:79], v169, s[36:39], 0 offen offset:64
    buffer_load_dwordx4 v[80:83], v169, s[36:39], 0 offen offset:96
    v_exp_f32 v42, v10
    v_exp_f32 v43, v11
    v_mfma_f32_32x32x16_bf16 v[20:35], v[100:103], v[128:131], v[20:35]
    v_exp_f32 v44, v12
    v_exp_f32 v45, v13
    v_exp_f32 v46, v14
    v_exp_f32 v47, v15
    v_mfma_f32_32x32x16_bf16 v[20:35], v[104:107], v[144:147], v[20:35]
    v_exp_f32 v48, v16
    v_exp_f32 v49, v17
    v_exp_f32 v50, v18
    v_exp_f32 v51, v19
    v_mfma_f32_32x32x16_bf16 a[48:63], v[108:111], v[60:63], a[48:63]
    v_add_f32 v36, 1.0, v36
    v_add_f32 v37, 1.0, v37
    ds_read_b32 v172, v168
    v_add_u32 v168, 128, v168
    v_add_f32 v38, 1.0, v38
    v_add_f32 v39, 1.0, v39
    v_add_f32 v40, 1.0, v40
    v_add_f32 v41, 1.0, v41
    v_add_f32 v42, 1.0, v42
    v_add_f32 v43, 1.0, v43
    v_mfma_f32_32x32x16_bf16 a[48:63], v[112:115], v[64:67], a[48:63]
    v_add_f32 v44, 1.0, v44
    v_add_f32 v45, 1.0, v45
    ds_read_b128 v[108:111], v176
    ds_read_b128 v[112:115], v176 offset:1024
    v_add_f32 v46, 1.0, v46
    v_add_f32 v47, 1.0, v47
    v_add_f32 v48, 1.0, v48
    v_add_f32 v49, 1.0, v49
    v_add_f32 v50, 1.0, v50
    v_add_f32 v51, 1.0, v51
    v_rcp_f32 v36, v36
    v_rcp_f32 v37, v37
    v_rcp_f32 v38, v38
    v_rcp_f32 v39, v39
    v_rcp_f32 v40, v40
    v_rcp_f32 v41, v41
    v_rcp_f32 v42, v42
    v_rcp_f32 v43, v43
    v_rcp_f32 v44, v44
    v_rcp_f32 v45, v45
    v_rcp_f32 v46, v46
    v_rcp_f32 v47, v47
    v_rcp_f32 v48, v48
    v_rcp_f32 v49, v49
    v_rcp_f32 v50, v50
    v_rcp_f32 v51, v51
    v_mul_f32 v4, v4, v36
    v_mul_f32 v5, v5, v37
    v_mul_f32 v6, v6, v38
    v_mul_f32 v7, v7, v39
    v_mul_f32 v8, v8, v40
    v_mul_f32 v9, v9, v41
    v_mul_f32 v10, v10, v42
    v_mul_f32 v11, v11, v43
    v_mul_f32 v12, v12, v44
    v_mul_f32 v13, v13, v45
    v_mul_f32 v14, v14, v46
    v_mul_f32 v15, v15, v47
    v_mul_f32 v16, v16, v48
    v_mul_f32 v17, v17, v49
    v_mul_f32 v18, v18, v50
    v_mul_f32 v19, v19, v51
    v_cvt_pk_bf16_f32 v52, v4, v5
    v_cvt_pk_bf16_f32 v53, v6, v7
    v_cvt_pk_bf16_f32 v54, v8, v9
    v_cvt_pk_bf16_f32 v55, v10, v11
    v_cvt_pk_bf16_f32 v56, v12, v13
    v_cvt_pk_bf16_f32 v57, v14, v15
    v_cvt_pk_bf16_f32 v58, v16, v17
    v_cvt_pk_bf16_f32 v59, v18, v19
    s_waitcnt vmcnt(7)
    v_mfma_f32_32x32x16_bf16 v[4:19], v[84:87], v[116:119], 0
    v_exp_f32 v36, v20
    v_exp_f32 v37, v21
    v_exp_f32 v38, v22
    v_exp_f32 v39, v23
    s_waitcnt vmcnt(6)
    v_mfma_f32_32x32x16_bf16 v[4:19], v[88:91], v[120:123], v[4:19]
    v_exp_f32 v40, v24
    v_exp_f32 v41, v25
    v_exp_f32 v42, v26
    v_exp_f32 v43, v27
    v_mfma_f32_32x32x16_bf16 v[4:19], v[100:103], v[132:135], v[4:19]
    v_exp_f32 v44, v28
    v_exp_f32 v45, v29
    v_exp_f32 v46, v30
    v_exp_f32 v47, v31
    v_mfma_f32_32x32x16_bf16 v[4:19], v[104:107], v[148:151], v[4:19]
    v_exp_f32 v48, v32
    v_exp_f32 v49, v33
    v_exp_f32 v50, v34
    v_exp_f32 v51, v35
    s_waitcnt lgkmcnt(1)
    v_mfma_f32_32x32x16_bf16 a[0:15], v[108:111], v[52:55], a[0:15]
    v_add_f32 v36, 1.0, v36
    v_add_f32 v37, 1.0, v37
    v_add_f32 v38, 1.0, v38
    v_add_f32 v39, 1.0, v39
    v_and_or_b32 v170, v172, s87, v2
    v_add_f32 v40, 1.0, v40
    v_add_f32 v41, 1.0, v41
    v_add_f32 v42, 1.0, v42
    v_add_f32 v43, 1.0, v43
    s_waitcnt lgkmcnt(0)
    v_mfma_f32_32x32x16_bf16 a[0:15], v[112:115], v[56:59], a[0:15]
    v_add_f32 v44, 1.0, v44
    v_add_f32 v45, 1.0, v45
    v_add_f32 v46, 1.0, v46
    v_add_f32 v47, 1.0, v47
    v_add_f32 v48, 1.0, v48
    v_add_f32 v49, 1.0, v49
    v_add_f32 v50, 1.0, v50
    v_add_f32 v51, 1.0, v51
    v_rcp_f32 v36, v36
    v_rcp_f32 v37, v37
    v_rcp_f32 v38, v38
    v_rcp_f32 v39, v39
    v_rcp_f32 v40, v40
    v_rcp_f32 v41, v41
    v_rcp_f32 v42, v42
    v_rcp_f32 v43, v43
    v_rcp_f32 v44, v44
    v_rcp_f32 v45, v45
    v_rcp_f32 v46, v46
    v_rcp_f32 v47, v47
    v_rcp_f32 v48, v48
    v_rcp_f32 v49, v49
    v_rcp_f32 v50, v50
    v_rcp_f32 v51, v51
    v_mul_f32 v20, v20, v36
    v_mul_f32 v21, v21, v37
    v_mul_f32 v22, v22, v38
    v_mul_f32 v23, v23, v39
    v_mul_f32 v24, v24, v40
    v_mul_f32 v25, v25, v41
    v_mul_f32 v26, v26, v42
    v_mul_f32 v27, v27, v43
    v_mul_f32 v28, v28, v44
    v_mul_f32 v29, v29, v45
    v_mul_f32 v30, v30, v46
    v_mul_f32 v31, v31, v47
    v_mul_f32 v32, v32, v48
    v_mul_f32 v33, v33, v49
    v_mul_f32 v34, v34, v50
    v_mul_f32 v35, v35, v51
    v_cvt_pk_bf16_f32 v60, v20, v21
    v_cvt_pk_bf16_f32 v61, v22, v23
    v_cvt_pk_bf16_f32 v62, v24, v25
    v_cvt_pk_bf16_f32 v63, v26, v27
    v_cvt_pk_bf16_f32 v64, v28, v29
    v_cvt_pk_bf16_f32 v65, v30, v31
    v_cvt_pk_bf16_f32 v66, v32, v33
    v_cvt_pk_bf16_f32 v67, v34, v35
    s_waitcnt vmcnt(5)
    v_mfma_f32_32x32x16_bf16 v[20:35], v[92:95], v[116:119], 0
    v_exp_f32 v36, v4
    v_exp_f32 v37, v5
    v_exp_f32 v38, v6
    v_exp_f32 v39, v7
    s_waitcnt vmcnt(4)
    v_mfma_f32_32x32x16_bf16 v[20:35], v[96:99], v[120:123], v[20:35]
    v_exp_f32 v40, v8
    v_exp_f32 v41, v9
    buffer_load_dwordx4 v[84:87], v169, s[36:39], 0 offen offset:128
    buffer_load_dwordx4 v[88:91], v169, s[36:39], 0 offen offset:160
    buffer_load_dwordx4 v[92:95], v169, s[36:39], 0 offen offset:192
    buffer_load_dwordx4 v[96:99], v169, s[36:39], 0 offen offset:224
    v_exp_f32 v42, v10
    v_exp_f32 v43, v11
    v_mfma_f32_32x32x16_bf16 v[20:35], v[100:103], v[136:139], v[20:35]
    v_exp_f32 v44, v12
    v_exp_f32 v45, v13
    v_exp_f32 v46, v14
    v_exp_f32 v47, v15
    v_mfma_f32_32x32x16_bf16 v[20:35], v[104:107], v[152:155], v[20:35]
    v_exp_f32 v48, v16
    v_exp_f32 v49, v17
    ds_read_b128 v[104:107], v167
    v_and_or_b32 v173, v171, s88, v2
    ds_read_b128 v[100:103], v173
    v_add_u32 v167, 512, v167
    v_exp_f32 v50, v18
    v_exp_f32 v51, v19
    v_mfma_f32_32x32x16_bf16 a[16:31], v[108:111], v[60:63], a[16:31]
    v_add_f32 v36, 1.0, v36
    v_add_f32 v37, 1.0, v37
    v_add_f32 v38, 1.0, v38
    v_add_f32 v39, 1.0, v39
    v_add_f32 v40, 1.0, v40
    v_add_f32 v41, 1.0, v41
    v_add_f32 v42, 1.0, v42
    v_add_f32 v43, 1.0, v43
    v_mfma_f32_32x32x16_bf16 a[16:31], v[112:115], v[64:67], a[16:31]
    v_add_f32 v44, 1.0, v44
    v_add_f32 v45, 1.0, v45
    v_add_f32 v46, 1.0, v46
    v_add_f32 v47, 1.0, v47
    v_add_f32 v48, 1.0, v48
    v_add_f32 v49, 1.0, v49
    v_add_f32 v50, 1.0, v50
    v_add_f32 v51, 1.0, v51
    v_rcp_f32 v36, v36
    v_rcp_f32 v37, v37
    v_rcp_f32 v38, v38
    v_rcp_f32 v39, v39
    v_rcp_f32 v40, v40
    v_rcp_f32 v41, v41
    v_rcp_f32 v42, v42
    v_rcp_f32 v43, v43
    v_rcp_f32 v44, v44
    v_rcp_f32 v45, v45
    v_rcp_f32 v46, v46
    v_rcp_f32 v47, v47
    v_rcp_f32 v48, v48
    v_rcp_f32 v49, v49
    v_rcp_f32 v50, v50
    v_rcp_f32 v51, v51
    v_mul_f32 v4, v4, v36
    v_mul_f32 v5, v5, v37
    v_mul_f32 v6, v6, v38
    v_mul_f32 v7, v7, v39
    v_mul_f32 v8, v8, v40
    v_mul_f32 v9, v9, v41
    v_mul_f32 v10, v10, v42
    v_mul_f32 v11, v11, v43
    v_mul_f32 v12, v12, v44
    v_mul_f32 v13, v13, v45
    v_mul_f32 v14, v14, v46
    v_mul_f32 v15, v15, v47
    v_mul_f32 v16, v16, v48
    v_mul_f32 v17, v17, v49
    v_mul_f32 v18, v18, v50
    v_mul_f32 v19, v19, v51
    v_cvt_pk_bf16_f32 v52, v4, v5
    v_cvt_pk_bf16_f32 v53, v6, v7
    v_cvt_pk_bf16_f32 v54, v8, v9
    v_cvt_pk_bf16_f32 v55, v10, v11
    v_cvt_pk_bf16_f32 v56, v12, v13
    v_cvt_pk_bf16_f32 v57, v14, v15
    v_cvt_pk_bf16_f32 v58, v16, v17
    v_cvt_pk_bf16_f32 v59, v18, v19
    s_waitcnt vmcnt(7)
    v_mfma_f32_32x32x16_bf16 v[4:19], v[68:71], v[116:119], 0
    v_exp_f32 v36, v20
    v_exp_f32 v37, v21
    v_exp_f32 v38, v22
    v_exp_f32 v39, v23
    s_waitcnt vmcnt(6)
    v_mfma_f32_32x32x16_bf16 v[4:19], v[72:75], v[120:123], v[4:19]
    v_exp_f32 v40, v24
    v_exp_f32 v41, v25
    v_exp_f32 v42, v26
    v_exp_f32 v43, v27
    s_waitcnt lgkmcnt(0)
    v_mfma_f32_32x32x16_bf16 v[4:19], v[100:103], v[124:127], v[4:19]
    v_exp_f32 v44, v28
    v_exp_f32 v45, v29
    v_exp_f32 v46, v30
    v_exp_f32 v47, v31
    v_mfma_f32_32x32x16_bf16 v[4:19], v[104:107], v[140:143], v[4:19]
    v_exp_f32 v48, v32
    v_exp_f32 v49, v33
    v_exp_f32 v50, v34
    v_exp_f32 v51, v35
    v_mfma_f32_32x32x16_bf16 a[32:47], v[108:111], v[52:55], a[32:47]
    v_add_f32 v36, 1.0, v36
    v_add_f32 v37, 1.0, v37
    v_add_f32 v38, 1.0, v38
    v_add_f32 v39, 1.0, v39
    v_add_f32 v40, 1.0, v40
    v_add_f32 v41, 1.0, v41
    v_add_f32 v42, 1.0, v42
    v_add_f32 v43, 1.0, v43
    v_mfma_f32_32x32x16_bf16 a[32:47], v[112:115], v[56:59], a[32:47]
    v_add_f32 v44, 1.0, v44
    v_add_f32 v45, 1.0, v45
    v_add_f32 v46, 1.0, v46
    v_add_f32 v47, 1.0, v47
    ds_write_b128 v176, v[156:159]
    ds_write_b128 v176, v[156:159] offset:1024
    v_add_f32 v48, 1.0, v48
    v_add_f32 v49, 1.0, v49
    v_add_f32 v50, 1.0, v50
    v_add_f32 v51, 1.0, v51
    v_rcp_f32 v36, v36
    v_rcp_f32 v37, v37
    v_rcp_f32 v38, v38
    v_rcp_f32 v39, v39
    v_rcp_f32 v40, v40
    v_rcp_f32 v41, v41
    v_rcp_f32 v42, v42
    v_rcp_f32 v43, v43
    v_lshl_add_u32 v174, v173, 1, v166
    v_and_or_b32 v175, v106, s89, v165
    v_cndmask_b32 v175, v175, v107, s[56:57]
    v_cmp_gt_u32 vcc, s53, v167
    s_nop 1
    v_cndmask_b32 v175, 0, v175, vcc
    ds_write_b16 v174, v175
    ds_write_b16_d16_hi v174, v175 offset:16
    v_rcp_f32 v44, v44
    v_rcp_f32 v45, v45
    v_rcp_f32 v46, v46
    v_rcp_f32 v47, v47
    v_rcp_f32 v48, v48
    v_rcp_f32 v49, v49
    v_rcp_f32 v50, v50
    v_rcp_f32 v51, v51
    v_mul_f32 v20, v20, v36
    v_mul_f32 v21, v21, v37
    v_mul_f32 v22, v22, v38
    v_mul_f32 v23, v23, v39
    v_mul_f32 v24, v24, v40
    v_mul_f32 v25, v25, v41
    v_mul_f32 v26, v26, v42
    v_mul_f32 v27, v27, v43
    v_mul_f32 v28, v28, v44
    v_mul_f32 v29, v29, v45
    v_mul_f32 v30, v30, v46
    v_mul_f32 v31, v31, v47
    v_mov_b32 v169, v170
    v_mov_b32 v171, v172
    v_mul_f32 v32, v32, v48
    v_mul_f32 v33, v33, v49
    v_mul_f32 v34, v34, v50
    v_mul_f32 v35, v35, v51
    v_cvt_pk_bf16_f32 v60, v20, v21
    v_cvt_pk_bf16_f32 v61, v22, v23
    v_cvt_pk_bf16_f32 v62, v24, v25
    v_cvt_pk_bf16_f32 v63, v26, v27
    v_cvt_pk_bf16_f32 v64, v28, v29
    v_cvt_pk_bf16_f32 v65, v30, v31
    v_cvt_pk_bf16_f32 v66, v32, v33
    v_cvt_pk_bf16_f32 v67, v34, v35
    s_sub_u32 s76, s76, 1
    s_cmp_lg_u32 s76, 0
    s_cbranch_scc1 K2_LOOP
K2_TAILCHK:
    s_cmp_eq_u32 s52, 0
    s_cbranch_scc1 K2_FIN2
    s_waitcnt vmcnt(5)
    v_mfma_f32_32x32x16_bf16 v[20:35], v[76:79], v[116:119], 0
    s_waitcnt vmcnt(4)
    v_mfma_f32_32x32x16_bf16 v[20:35], v[80:83], v[120:123], v[20:35]
    v_mfma_f32_32x32x16_bf16 v[20:35], v[100:103], v[128:131], v[20:35]
    v_mfma_f32_32x32x16_bf16 v[20:35], v[104:107], v[144:147], v[20:35]
    v_mfma_f32_32x32x16_bf16 a[48:63], v[108:111], v[60:63], a[48:63]
    v_mfma_f32_32x32x16_bf16 a[48:63], v[112:115], v[64:67], a[48:63]
    ds_read_b128 v[108:111], v176
    ds_read_b128 v[112:115], v176 offset:1024
    v_exp_f32 v36, v4
    v_exp_f32 v37, v5
    v_exp_f32 v38, v6
    v_exp_f32 v39, v7
    v_add_f32 v36, 1.0, v36
    v_add_f32 v37, 1.0, v37
    v_add_f32 v38, 1.0, v38
    v_add_f32 v39, 1.0, v39
    v_rcp_f32 v36, v36
    v_rcp_f32 v37, v37
    v_rcp_f32 v38, v38
    v_rcp_f32 v39, v39
    v_mul_f32 v4, v4, v36
    v_mul_f32 v5, v5, v37
    v_mul_f32 v6, v6, v38
    v_mul_f32 v7, v7, v39
    v_cvt_pk_bf16_f32 v52, v4, v5
    v_cvt_pk_bf16_f32 v53, v6, v7
    s_cmp_le_u32 s52, 8
    s_cbranch_scc1 K2_TSKIP0
    v_exp_f32 v40, v8
    v_exp_f32 v41, v9
    v_exp_f32 v42, v10
    v_exp_f32 v43, v11
    v_add_f32 v40, 1.0, v40
    v_add_f32 v41, 1.0, v41
    v_add_f32 v42, 1.0, v42
    v_add_f32 v43, 1.0, v43
    v_rcp_f32 v40, v40
    v_rcp_f32 v41, v41
    v_rcp_f32 v42, v42
    v_rcp_f32 v43, v43
    v_mul_f32 v8, v8, v40
    v_mul_f32 v9, v9, v41
    v_mul_f32 v10, v10, v42
    v_mul_f32 v11, v11, v43
    v_cvt_pk_bf16_f32 v54, v8, v9
    v_cvt_pk_bf16_f32 v55, v10, v11
    s_cmp_le_u32 s52, 16
    s_cbranch_scc1 K2_TSKIP0
    v_exp_f32 v44, v12
    v_exp_f32 v45, v13
    v_exp_f32 v46, v14
    v_exp_f32 v47, v15
    v_add_f32 v44, 1.0, v44
    v_add_f32 v45, 1.0, v45
    v_add_f32 v46, 1.0, v46
    v_add_f32 v47, 1.0, v47
    v_rcp_f32 v44, v44
    v_rcp_f32 v45, v45
    v_rcp_f32 v46, v46
    v_rcp_f32 v47, v47
    v_mul_f32 v12, v12, v44
    v_mul_f32 v13, v13, v45
    v_mul_f32 v14, v14, v46
    v_mul_f32 v15, v15, v47
    v_cvt_pk_bf16_f32 v56, v12, v13
    v_cvt_pk_bf16_f32 v57, v14, v15
    s_cmp_le_u32 s52, 24
    s_cbranch_scc1 K2_TSKIP0
    v_exp_f32 v48, v16
    v_exp_f32 v49, v17
    v_exp_f32 v50, v18
    v_exp_f32 v51, v19
    v_add_f32 v48, 1.0, v48
    v_add_f32 v49, 1.0, v49
    v_add_f32 v50, 1.0, v50
    v_add_f32 v51, 1.0, v51
    v_rcp_f32 v48, v48
    v_rcp_f32 v49, v49
    v_rcp_f32 v50, v50
    v_rcp_f32 v51, v51
    v_mul_f32 v16, v16, v48
    v_mul_f32 v17, v17, v49
    v_mul_f32 v18, v18, v50
    v_mul_f32 v19, v19, v51
    v_cvt_pk_bf16_f32 v58, v16, v17
    v_cvt_pk_bf16_f32 v59, v18, v19
K2_TSKIP0:
    s_waitcnt vmcnt(3)
    v_mfma_f32_32x32x16_bf16 v[4:19], v[84:87], v[116:119], 0
    s_waitcnt vmcnt(2)
    v_mfma_f32_32x32x16_bf16 v[4:19], v[88:91], v[120:123], v[4:19]
    v_mfma_f32_32x32x16_bf16 v[4:19], v[100:103], v[132:135], v[4:19]
    v_mfma_f32_32x32x16_bf16 v[4:19], v[104:107], v[148:151], v[4:19]
    s_waitcnt lgkmcnt(1)
    v_mfma_f32_32x32x16_bf16 a[0:15], v[108:111], v[52:55], a[0:15]
    s_waitcnt lgkmcnt(0)
    v_mfma_f32_32x32x16_bf16 a[0:15], v[112:115], v[56:59], a[0:15]
    v_exp_f32 v36, v20
    v_exp_f32 v37, v21
    v_exp_f32 v38, v22
    v_exp_f32 v39, v23
    v_add_f32 v36, 1.0, v36
    v_add_f32 v37, 1.0, v37
    v_add_f32 v38, 1.0, v38
    v_add_f32 v39, 1.0, v39
    v_rcp_f32 v36, v36
    v_rcp_f32 v37, v37
    v_rcp_f32 v38, v38
    v_rcp_f32 v39, v39
    v_mul_f32 v20, v20, v36
    v_mul_f32 v21, v21, v37
    v_mul_f32 v22, v22, v38
    v_mul_f32 v23, v23, v39
    v_cvt_pk_bf16_f32 v60, v20, v21
    v_cvt_pk_bf16_f32 v61, v22, v23
    s_cmp_le_u32 s52, 8
    s_cbranch_scc1 K2_TSKIP1
    v_exp_f32 v40, v24
    v_exp_f32 v41, v25
    v_exp_f32 v42, v26
    v_exp_f32 v43, v27
    v_add_f32 v40, 1.0, v40
    v_add_f32 v41, 1.0, v41
    v_add_f32 v42, 1.0, v42
    v_add_f32 v43, 1.0, v43
    v_rcp_f32 v40, v40
    v_rcp_f32 v41, v41
    v_rcp_f32 v42, v42
    v_rcp_f32 v43, v43
    v_mul_f32 v24, v24, v40
    v_mul_f32 v25, v25, v41
    v_mul_f32 v26, v26, v42
    v_mul_f32 v27, v27, v43
    v_cvt_pk_bf16_f32 v62, v24, v25
    v_cvt_pk_bf16_f32 v63, v26, v27
    s_cmp_le_u32 s52, 16
    s_cbranch_scc1 K2_TSKIP1
    v_exp_f32 v44, v28
    v_exp_f32 v45, v29
    v_exp_f32 v46, v30
    v_exp_f32 v47, v31
    v_add_f32 v44, 1.0, v44
    v_add_f32 v45, 1.0, v45
    v_add_f32 v46, 1.0, v46
    v_add_f32 v47, 1.0, v47
    v_rcp_f32 v44, v44
    v_rcp_f32 v45, v45
    v_rcp_f32 v46, v46
    v_rcp_f32 v47, v47
    v_mul_f32 v28, v28, v44
    v_mul_f32 v29, v29, v45
    v_mul_f32 v30, v30, v46
    v_mul_f32 v31, v31, v47
    v_cvt_pk_bf16_f32 v64, v28, v29
    v_cvt_pk_bf16_f32 v65, v30, v31
    s_cmp_le_u32 s52, 24
    s_cbranch_scc1 K2_TSKIP1
    v_exp_f32 v48, v32
    v_exp_f32 v49, v33
    v_exp_f32 v50, v34
    v_exp_f32 v51, v35
    v_add_f32 v48, 1.0, v48
    v_add_f32 v49, 1.0, v49
    v_add_f32 v50, 1.0, v50
    v_add_f32 v51, 1.0, v51
    v_rcp_f32 v48, v48
    v_rcp_f32 v49, v49
    v_rcp_f32 v50, v50
    v_rcp_f32 v51, v51
    v_mul_f32 v32, v32, v48
    v_mul_f32 v33, v33, v49
    v_mul_f32 v34, v34, v50
    v_mul_f32 v35, v35, v51
    v_cvt_pk_bf16_f32 v66, v32, v33
    v_cvt_pk_bf16_f32 v67, v34, v35
K2_TSKIP1:
    s_waitcnt vmcnt(1)
    v_mfma_f32_32x32x16_bf16 v[20:35], v[92:95], v[116:119], 0
    s_waitcnt vmcnt(0)
    v_mfma_f32_32x32x16_bf16 v[20:35], v[96:99], v[120:123], v[20:35]
    v_mfma_f32_32x32x16_bf16 v[20:35], v[100:103], v[136:139], v[20:35]
    v_mfma_f32_32x32x16_bf16 v[20:35], v[104:107], v[152:155], v[20:35]
    v_mfma_f32_32x32x16_bf16 a[16:31], v[108:111], v[60:63], a[16:31]
    v_mfma_f32_32x32x16_bf16 a[16:31], v[112:115], v[64:67], a[16:31]
    v_exp_f32 v36, v4
    v_exp_f32 v37, v5
    v_exp_f32 v38, v6
    v_exp_f32 v39, v7
    v_add_f32 v36, 1.0, v36
    v_add_f32 v37, 1.0, v37
    v_add_f32 v38, 1.0, v38
    v_add_f32 v39, 1.0, v39
    v_rcp_f32 v36, v36
    v_rcp_f32 v37, v37
    v_rcp_f32 v38, v38
    v_rcp_f32 v39, v39
    v_mul_f32 v4, v4, v36
    v_mul_f32 v5, v5, v37
    v_mul_f32 v6, v6, v38
    v_mul_f32 v7, v7, v39
    v_cvt_pk_bf16_f32 v52, v4, v5
    v_cvt_pk_bf16_f32 v53, v6, v7
    s_cmp_le_u32 s52, 8
    s_cbranch_scc1 K2_TSKIP2
    v_exp_f32 v40, v8
    v_exp_f32 v41, v9
    v_exp_f32 v42, v10
    v_exp_f32 v43, v11
    v_add_f32 v40, 1.0, v40
    v_add_f32 v41, 1.0, v41
    v_add_f32 v42, 1.0, v42
    v_add_f32 v43, 1.0, v43
    v_rcp_f32 v40, v40
    v_rcp_f32 v41, v41
    v_rcp_f32 v42, v42
    v_rcp_f32 v43, v43
    v_mul_f32 v8, v8, v40
    v_mul_f32 v9, v9, v41
    v_mul_f32 v10, v10, v42
    v_mul_f32 v11, v11, v43
    v_cvt_pk_bf16_f32 v54, v8, v9
    v_cvt_pk_bf16_f32 v55, v10, v11
    s_cmp_le_u32 s52, 16
    s_cbranch_scc1 K2_TSKIP2
    v_exp_f32 v44, v12
    v_exp_f32 v45, v13
    v_exp_f32 v46, v14
    v_exp_f32 v47, v15
    v_add_f32 v44, 1.0, v44
    v_add_f32 v45, 1.0, v45
    v_add_f32 v46, 1.0, v46
    v_add_f32 v47, 1.0, v47
    v_rcp_f32 v44, v44
    v_rcp_f32 v45, v45
    v_rcp_f32 v46, v46
    v_rcp_f32 v47, v47
    v_mul_f32 v12, v12, v44
    v_mul_f32 v13, v13, v45
    v_mul_f32 v14, v14, v46
    v_mul_f32 v15, v15, v47
    v_cvt_pk_bf16_f32 v56, v12, v13
    v_cvt_pk_bf16_f32 v57, v14, v15
    s_cmp_le_u32 s52, 24
    s_cbranch_scc1 K2_TSKIP2
    v_exp_f32 v48, v16
    v_exp_f32 v49, v17
    v_exp_f32 v50, v18
    v_exp_f32 v51, v19
    v_add_f32 v48, 1.0, v48
    v_add_f32 v49, 1.0, v49
    v_add_f32 v50, 1.0, v50
    v_add_f32 v51, 1.0, v51
    v_rcp_f32 v48, v48
    v_rcp_f32 v49, v49
    v_rcp_f32 v50, v50
    v_rcp_f32 v51, v51
    v_mul_f32 v16, v16, v48
    v_mul_f32 v17, v17, v49
    v_mul_f32 v18, v18, v50
    v_mul_f32 v19, v19, v51
    v_cvt_pk_bf16_f32 v58, v16, v17
    v_cvt_pk_bf16_f32 v59, v18, v19
K2_TSKIP2:
    v_mfma_f32_32x32x16_bf16 a[32:47], v[108:111], v[52:55], a[32:47]
    s_nop 0
    v_mfma_f32_32x32x16_bf16 a[32:47], v[112:115], v[56:59], a[32:47]
    v_exp_f32 v36, v20
    v_exp_f32 v37, v21
    v_exp_f32 v38, v22
    v_exp_f32 v39, v23
    v_add_f32 v36, 1.0, v36
    v_add_f32 v37, 1.0, v37
    v_add_f32 v38, 1.0, v38
    v_add_f32 v39, 1.0, v39
    v_rcp_f32 v36, v36
    v_rcp_f32 v37, v37
    v_rcp_f32 v38, v38
    v_rcp_f32 v39, v39
    v_mul_f32 v20, v20, v36
    v_mul_f32 v21, v21, v37
    v_mul_f32 v22, v22, v38
    v_mul_f32 v23, v23, v39
    v_cvt_pk_bf16_f32 v60, v20, v21
    v_cvt_pk_bf16_f32 v61, v22, v23
    s_cmp_le_u32 s52, 8
    s_cbranch_scc1 K2_TSKIP3
    v_exp_f32 v40, v24
    v_exp_f32 v41, v25
    v_exp_f32 v42, v26
    v_exp_f32 v43, v27
    v_add_f32 v40, 1.0, v40
    v_add_f32 v41, 1.0, v41
    v_add_f32 v42, 1.0, v42
    v_add_f32 v43, 1.0, v43
    v_rcp_f32 v40, v40
    v_rcp_f32 v41, v41
    v_rcp_f32 v42, v42
    v_rcp_f32 v43, v43
    v_mul_f32 v24, v24, v40
    v_mul_f32 v25, v25, v41
    v_mul_f32 v26, v26, v42
    v_mul_f32 v27, v27, v43
    v_cvt_pk_bf16_f32 v62, v24, v25
    v_cvt_pk_bf16_f32 v63, v26, v27
    s_cmp_le_u32 s52, 16
    s_cbranch_scc1 K2_TSKIP3
    v_exp_f32 v44, v28
    v_exp_f32 v45, v29
    v_exp_f32 v46, v30
    v_exp_f32 v47, v31
    v_add_f32 v44, 1.0, v44
    v_add_f32 v45, 1.0, v45
    v_add_f32 v46, 1.0, v46
    v_add_f32 v47, 1.0, v47
    v_rcp_f32 v44, v44
    v_rcp_f32 v45, v45
    v_rcp_f32 v46, v46
    v_rcp_f32 v47, v47
    v_mul_f32 v28, v28, v44
    v_mul_f32 v29, v29, v45
    v_mul_f32 v30, v30, v46
    v_mul_f32 v31, v31, v47
    v_cvt_pk_bf16_f32 v64, v28, v29
    v_cvt_pk_bf16_f32 v65, v30, v31
    s_cmp_le_u32 s52, 24
    s_cbranch_scc1 K2_TSKIP3
    v_exp_f32 v48, v32
    v_exp_f32 v49, v33
    v_exp_f32 v50, v34
    v_exp_f32 v51, v35
    v_add_f32 v48, 1.0, v48
    v_add_f32 v49, 1.0, v49
    v_add_f32 v50, 1.0, v50
    v_add_f32 v51, 1.0, v51
    v_rcp_f32 v48, v48
    v_rcp_f32 v49, v49
    v_rcp_f32 v50, v50
    v_rcp_f32 v51, v51
    v_mul_f32 v32, v32, v48
    v_mul_f32 v33, v33, v49
    v_mul_f32 v34, v34, v50
    v_mul_f32 v35, v35, v51
    v_cvt_pk_bf16_f32 v66, v32, v33
    v_cvt_pk_bf16_f32 v67, v34, v35
K2_TSKIP3:
K2_FIN2:
    v_mfma_f32_32x32x16_bf16 a[48:63], v[108:111], v[60:63], a[48:63]
    s_nop 0
    v_mfma_f32_32x32x16_bf16 a[48:63], v[112:115], v[64:67], a[48:63]
    s_add_u32 s49, s49, 288
    s_cmp_lt_u32 s49, s48
    s_cbranch_scc1 K2_WIN
    ds_read_b128 v[68:71], v191 offset:0
    ds_read_b128 v[72:75], v191 offset:32
    s_waitcnt vmcnt(5)
    ds_read_b128 v[76:79], v191 offset:64
    s_waitcnt vmcnt(4)
    ds_read_b128 v[80:83], v191 offset:96
    s_waitcnt vmcnt(3)
    ds_read_b128 v[84:87], v191 offset:128
    s_waitcnt vmcnt(2)
    ds_read_b128 v[88:91], v191 offset:160
    s_waitcnt vmcnt(1)
    ds_read_b128 v[92:95], v191 offset:192
    s_waitcnt vmcnt(0)
    ds_read_b128 v[96:99], v191 offset:224
    s_add_u32 s84, s74, 32768
    buffer_load_dwordx4 v[124:127], v164, s[40:43], s84 offen
    s_add_u32 s84, s74, 36864
    buffer_load_dwordx4 v[128:131], v164, s[40:43], s84 offen
    s_add_u32 s84, s74, 40960
    buffer_load_dwordx4 v[132:135], v164, s[40:43], s84 offen
    s_add_u32 s84, s74, 45056
    buffer_load_dwordx4 v[136:139], v164, s[40:43], s84 offen
    s_add_u32 s84, s74, 49152
    buffer_load_dwordx4 v[140:143], v164, s[40:43], s84 offen
    s_add_u32 s84, s74, 53248
    buffer_load_dwordx4 v[144:147], v164, s[40:43], s84 offen
    s_add_u32 s84, s74, 57344
    buffer_load_dwordx4 v[148:151], v164, s[40:43], s84 offen
    s_add_u32 s84, s74, 61440
    buffer_load_dwordx4 v[152:155], v164, s[40:43], s84 offen
    s_add_u32 s84, s74, 65536
    buffer_load_dwordx4 v[36:39], v164, s[40:43], s84 offen
    s_add_u32 s84, s74, 69632
    buffer_load_dwordx4 v[40:43], v164, s[40:43], s84 offen
    s_add_u32 s84, s74, 73728
    buffer_load_dwordx4 v[44:47], v164, s[40:43], s84 offen
    s_add_u32 s84, s74, 77824
    buffer_load_dwordx4 v[48:51], v164, s[40:43], s84 offen
    s_add_u32 s84, s74, 81920
    buffer_load_dwordx4 v[116:119], v164, s[40:43], s84 offen
    s_add_u32 s84, s74, 86016
    buffer_load_dwordx4 v[120:123], v164, s[40:43], s84 offen
    s_add_u32 s84, s74, 90112
    buffer_load_dwordx4 v[100:103], v164, s[40:43], s84 offen
    s_add_u32 s84, s74, 94208
    buffer_load_dwordx4 v[104:107], v164, s[40:43], s84 offen
    s_mov_b32 s76, 0xbf317218
    s_lshl_b32 s77, s75, 11
    s_add_u32 s77, s77, 95488
    v_lshlrev_b32 v178, 4, v2
    v_lshl_add_u32 v178, v1, 1, v178
    v_add_u32 v178, s77, v178
    v_accvgpr_read_b32 v4, a0
    v_accvgpr_read_b32 v5, a4
    v_accvgpr_read_b32 v6, a8
    v_accvgpr_read_b32 v7, a12
    v_accvgpr_read_b32 v8, a16
    v_accvgpr_read_b32 v9, a20
    v_accvgpr_read_b32 v10, a24
    v_accvgpr_read_b32 v11, a28
    v_accvgpr_read_b32 v12, a32
    v_accvgpr_read_b32 v13, a36
    v_accvgpr_read_b32 v14, a40
    v_accvgpr_read_b32 v15, a44
    v_accvgpr_read_b32 v16, a48
    v_accvgpr_read_b32 v17, a52
    v_accvgpr_read_b32 v18, a56
    v_accvgpr_read_b32 v19, a60
    v_mul_f32 v4, s76, v4
    v_cvt_pk_bf16_f32 v4, v4, v4
    ds_write_b16 v178, v4 offset:0
    v_mul_f32 v5, s76, v5
    v_cvt_pk_bf16_f32 v5, v5, v5
    ds_write_b16 v178, v5 offset:512
    v_mul_f32 v6, s76, v6
    v_cvt_pk_bf16_f32 v6, v6, v6
    ds_write_b16 v178, v6 offset:1024
    v_mul_f32 v7, s76, v7
    v_cvt_pk_bf16_f32 v7, v7, v7
    ds_write_b16 v178, v7 offset:1536
    v_mul_f32 v8, s76, v8
    v_cvt_pk_bf16_f32 v8, v8, v8
    ds_write_b16 v178, v8 offset:64
    v_mul_f32 v9, s76, v9
    v_cvt_pk_bf16_f32 v9, v9, v9
    ds_write_b16 v178, v9 offset:576
    v_mul_f32 v10, s76, v10
    v_cvt_pk_bf16_f32 v10, v10, v10
    ds_write_b16 v178, v10 offset:1088
    v_mul_f32 v11, s76, v11
    v_cvt_pk_bf16_f32 v11, v11, v11
    ds_write_b16 v178, v11 offset:1600
    v_mul_f32 v12, s76, v12
    v_cvt_pk_bf16_f32 v12, v12, v12
    ds_write_b16 v178, v12 offset:128
    v_mul_f32 v13, s76, v13
    v_cvt_pk_bf16_f32 v13, v13, v13
    ds_write_b16 v178, v13 offset:640
    v_mul_f32 v14, s76, v14
    v_cvt_pk_bf16_f32 v14, v14, v14
    ds_write_b16 v178, v14 offset:1152
    v_mul_f32 v15, s76, v15
    v_cvt_pk_bf16_f32 v15, v15, v15
    ds_write_b16 v178, v15 offset:1664
    v_mul_f32 v16, s76, v16
    v_cvt_pk_bf16_f32 v16, v16, v16
    ds_write_b16 v178, v16 offset:192
    v_mul_f32 v17, s76, v17
    v_cvt_pk_bf16_f32 v17, v17, v17
    ds_write_b16 v178, v17 offset:704
    v_mul_f32 v18, s76, v18
    v_cvt_pk_bf16_f32 v18, v18, v18
    ds_write_b16 v178, v18 offset:1216
    v_mul_f32 v19, s76, v19
    v_cvt_pk_bf16_f32 v19, v19, v19
    ds_write_b16 v178, v19 offset:1728
    v_accvgpr_read_b32 v179, a1
    v_mul_f32 v20, v179, v160
    v_accvgpr_read_b32 v179, a17
    v_fmac_f32 v20, v179, v161
    v_accvgpr_read_b32 v179, a33
    v_fmac_f32 v20, v179, v162
    v_accvgpr_read_b32 v179, a49
    v_fmac_f32 v20, v179, v163
    v_accvgpr_read_b32 v179, a2
    v_mul_f32 v21, v179, v160
    v_accvgpr_read_b32 v179, a18
    v_fmac_f32 v21, v179, v161
    v_accvgpr_read_b32 v179, a34
    v_fmac_f32 v21, v179, v162
    v_accvgpr_read_b32 v179, a50
    v_fmac_f32 v21, v179, v163
    v_accvgpr_read_b32 v179, a3
    v_mul_f32 v22, v179, v160
    v_accvgpr_read_b32 v179, a19
    v_fmac_f32 v22, v179, v161
    v_accvgpr_read_b32 v179, a35
    v_fmac_f32 v22, v179, v162
    v_accvgpr_read_b32 v179, a51
    v_fmac_f32 v22, v179, v163
    v_accvgpr_read_b32 v179, a5
    v_mul_f32 v23, v179, v160
    v_accvgpr_read_b32 v179, a21
    v_fmac_f32 v23, v179, v161
    v_accvgpr_read_b32 v179, a37
    v_fmac_f32 v23, v179, v162
    v_accvgpr_read_b32 v179, a53
    v_fmac_f32 v23, v179, v163
    v_accvgpr_read_b32 v179, a6
    v_mul_f32 v24, v179, v160
    v_accvgpr_read_b32 v179, a22
    v_fmac_f32 v24, v179, v161
    v_accvgpr_read_b32 v179, a38
    v_fmac_f32 v24, v179, v162
    v_accvgpr_read_b32 v179, a54
    v_fmac_f32 v24, v179, v163
    v_accvgpr_read_b32 v179, a7
    v_mul_f32 v25, v179, v160
    v_accvgpr_read_b32 v179, a23
    v_fmac_f32 v25, v179, v161
    v_accvgpr_read_b32 v179, a39
    v_fmac_f32 v25, v179, v162
    v_accvgpr_read_b32 v179, a55
    v_fmac_f32 v25, v179, v163
    v_accvgpr_read_b32 v179, a9
    v_mul_f32 v26, v179, v160
    v_accvgpr_read_b32 v179, a25
    v_fmac_f32 v26, v179, v161
    v_accvgpr_read_b32 v179, a41
    v_fmac_f32 v26, v179, v162
    v_accvgpr_read_b32 v179, a57
    v_fmac_f32 v26, v179, v163
    v_accvgpr_read_b32 v179, a10
    v_mul_f32 v27, v179, v160
    v_accvgpr_read_b32 v179, a26
    v_fmac_f32 v27, v179, v161
    v_accvgpr_read_b32 v179, a42
    v_fmac_f32 v27, v179, v162
    v_accvgpr_read_b32 v179, a58
    v_fmac_f32 v27, v179, v163
    v_accvgpr_read_b32 v179, a11
    v_mul_f32 v28, v179, v160
    v_accvgpr_read_b32 v179, a27
    v_fmac_f32 v28, v179, v161
    v_accvgpr_read_b32 v179, a43
    v_fmac_f32 v28, v179, v162
    v_accvgpr_read_b32 v179, a59
    v_fmac_f32 v28, v179, v163
    v_accvgpr_read_b32 v179, a13
    v_mul_f32 v29, v179, v160
    v_accvgpr_read_b32 v179, a29
    v_fmac_f32 v29, v179, v161
    v_accvgpr_read_b32 v179, a45
    v_fmac_f32 v29, v179, v162
    v_accvgpr_read_b32 v179, a61
    v_fmac_f32 v29, v179, v163
    v_accvgpr_read_b32 v179, a14
    v_mul_f32 v30, v179, v160
    v_accvgpr_read_b32 v179, a30
    v_fmac_f32 v30, v179, v161
    v_accvgpr_read_b32 v179, a46
    v_fmac_f32 v30, v179, v162
    v_accvgpr_read_b32 v179, a62
    v_fmac_f32 v30, v179, v163
    v_accvgpr_read_b32 v179, a15
    v_mul_f32 v31, v179, v160
    v_accvgpr_read_b32 v179, a31
    v_fmac_f32 v31, v179, v161
    v_accvgpr_read_b32 v179, a47
    v_fmac_f32 v31, v179, v162
    v_accvgpr_read_b32 v179, a63
    v_fmac_f32 v31, v179, v163
    v_add_f32_dpp v20, v20, v20 row_shr:1 row_mask:0xf bank_mask:0xf bound_ctrl:0
    v_add_f32_dpp v21, v21, v21 row_shr:1 row_mask:0xf bank_mask:0xf bound_ctrl:0
    v_add_f32_dpp v22, v22, v22 row_shr:1 row_mask:0xf bank_mask:0xf bound_ctrl:0
    v_add_f32_dpp v23, v23, v23 row_shr:1 row_mask:0xf bank_mask:0xf bound_ctrl:0
    v_add_f32_dpp v24, v24, v24 row_shr:1 row_mask:0xf bank_mask:0xf bound_ctrl:0
    v_add_f32_dpp v25, v25, v25 row_shr:1 row_mask:0xf bank_mask:0xf bound_ctrl:0
    v_add_f32_dpp v26, v26, v26 row_shr:1 row_mask:0xf bank_mask:0xf bound_ctrl:0
    v_add_f32_dpp v27, v27, v27 row_shr:1 row_mask:0xf bank_mask:0xf bound_ctrl:0
    v_add_f32_dpp v28, v28, v28 row_shr:1 row_mask:0xf bank_mask:0xf bound_ctrl:0
    v_add_f32_dpp v29, v29, v29 row_shr:1 row_mask:0xf bank_mask:0xf bound_ctrl:0
    v_add_f32_dpp v30, v30, v30 row_shr:1 row_mask:0xf bank_mask:0xf bound_ctrl:0
    v_add_f32_dpp v31, v31, v31 row_shr:1 row_mask:0xf bank_mask:0xf bound_ctrl:0
    v_add_f32_dpp v20, v20, v20 row_shr:2 row_mask:0xf bank_mask:0xf bound_ctrl:0
    v_add_f32_dpp v21, v21, v21 row_shr:2 row_mask:0xf bank_mask:0xf bound_ctrl:0
    v_add_f32_dpp v22, v22, v22 row_shr:2 row_mask:0xf bank_mask:0xf bound_ctrl:0
    v_add_f32_dpp v23, v23, v23 row_shr:2 row_mask:0xf bank_mask:0xf bound_ctrl:0
    v_add_f32_dpp v24, v24, v24 row_shr:2 row_mask:0xf bank_mask:0xf bound_ctrl:0
    v_add_f32_dpp v25, v25, v25 row_shr:2 row_mask:0xf bank_mask:0xf bound_ctrl:0
    v_add_f32_dpp v26, v26, v26 row_shr:2 row_mask:0xf bank_mask:0xf bound_ctrl:0
    v_add_f32_dpp v27, v27, v27 row_shr:2 row_mask:0xf bank_mask:0xf bound_ctrl:0
    v_add_f32_dpp v28, v28, v28 row_shr:2 row_mask:0xf bank_mask:0xf bound_ctrl:0
    v_add_f32_dpp v29, v29, v29 row_shr:2 row_mask:0xf bank_mask:0xf bound_ctrl:0
    v_add_f32_dpp v30, v30, v30 row_shr:2 row_mask:0xf bank_mask:0xf bound_ctrl:0
    v_add_f32_dpp v31, v31, v31 row_shr:2 row_mask:0xf bank_mask:0xf bound_ctrl:0
    v_add_f32_dpp v20, v20, v20 row_shr:4 row_mask:0xf bank_mask:0xf bound_ctrl:0
    v_add_f32_dpp v21, v21, v21 row_shr:4 row_mask:0xf bank_mask:0xf bound_ctrl:0
    v_add_f32_dpp v22, v22, v22 row_shr:4 row_mask:0xf bank_mask:0xf bound_ctrl:0
    v_add_f32_dpp v23, v23, v23 row_shr:4 row_mask:0xf bank_mask:0xf bound_ctrl:0
    v_add_f32_dpp v24, v24, v24 row_shr:4 row_mask:0xf bank_mask:0xf bound_ctrl:0
    v_add_f32_dpp v25, v25, v25 row_shr:4 row_mask:0xf bank_mask:0xf bound_ctrl:0
    v_add_f32_dpp v26, v26, v26 row_shr:4 row_mask:0xf bank_mask:0xf bound_ctrl:0
    v_add_f32_dpp v27, v27, v27 row_shr:4 row_mask:0xf bank_mask:0xf bound_ctrl:0
    v_add_f32_dpp v28, v28, v28 row_shr:4 row_mask:0xf bank_mask:0xf bound_ctrl:0
    v_add_f32_dpp v29, v29, v29 row_shr:4 row_mask:0xf bank_mask:0xf bound_ctrl:0
    v_add_f32_dpp v30, v30, v30 row_shr:4 row_mask:0xf bank_mask:0xf bound_ctrl:0
    v_add_f32_dpp v31, v31, v31 row_shr:4 row_mask:0xf bank_mask:0xf bound_ctrl:0
    v_add_f32_dpp v20, v20, v20 row_shr:8 row_mask:0xf bank_mask:0xf bound_ctrl:0
    v_add_f32_dpp v21, v21, v21 row_shr:8 row_mask:0xf bank_mask:0xf bound_ctrl:0
    v_add_f32_dpp v22, v22, v22 row_shr:8 row_mask:0xf bank_mask:0xf bound_ctrl:0
    v_add_f32_dpp v23, v23, v23 row_shr:8 row_mask:0xf bank_mask:0xf bound_ctrl:0
    v_add_f32_dpp v24, v24, v24 row_shr:8 row_mask:0xf bank_mask:0xf bound_ctrl:0
    v_add_f32_dpp v25, v25, v25 row_shr:8 row_mask:0xf bank_mask:0xf bound_ctrl:0
    v_add_f32_dpp v26, v26, v26 row_shr:8 row_mask:0xf bank_mask:0xf bound_ctrl:0
    v_add_f32_dpp v27, v27, v27 row_shr:8 row_mask:0xf bank_mask:0xf bound_ctrl:0
    v_add_f32_dpp v28, v28, v28 row_shr:8 row_mask:0xf bank_mask:0xf bound_ctrl:0
    v_add_f32_dpp v29, v29, v29 row_shr:8 row_mask:0xf bank_mask:0xf bound_ctrl:0
    v_add_f32_dpp v30, v30, v30 row_shr:8 row_mask:0xf bank_mask:0xf bound_ctrl:0
    v_add_f32_dpp v31, v31, v31 row_shr:8 row_mask:0xf bank_mask:0xf bound_ctrl:0
    v_add_f32_dpp v20, v20, v20 row_bcast:15 row_mask:0xa bank_mask:0xf
    v_add_f32_dpp v21, v21, v21 row_bcast:15 row_mask:0xa bank_mask:0xf
    v_add_f32_dpp v22, v22, v22 row_bcast:15 row_mask:0xa bank_mask:0xf
    v_add_f32_dpp v23, v23, v23 row_bcast:15 row_mask:0xa bank_mask:0xf
    v_add_f32_dpp v24, v24, v24 row_bcast:15 row_mask:0xa bank_mask:0xf
    v_add_f32_dpp v25, v25, v25 row_bcast:15 row_mask:0xa bank_mask:0xf
    v_add_f32_dpp v26, v26, v26 row_bcast:15 row_mask:0xa bank_mask:0xf
    v_add_f32_dpp v27, v27, v27 row_bcast:15 row_mask:0xa bank_mask:0xf
    v_add_f32_dpp v28, v28, v28 row_bcast:15 row_mask:0xa bank_mask:0xf
    v_add_f32_dpp v29, v29, v29 row_bcast:15 row_mask:0xa bank_mask:0xf
    v_add_f32_dpp v30, v30, v30 row_bcast:15 row_mask:0xa bank_mask:0xf
    v_add_f32_dpp v31, v31, v31 row_bcast:15 row_mask:0xa bank_mask:0xf
    v_lshrrev_b32 v179, 4, v2
    v_mul_u32_u24 v179, 12, v179
    v_add_u32 v179, s54, v179
    s_mov_b32 exec_lo, 0x80000000
    s_mov_b32 exec_hi, 0x80000000
    ds_write_b32 v179, v20 offset:0
    ds_write_b32 v179, v21 offset:4
    ds_write_b32 v179, v22 offset:8
    ds_write_b32 v179, v23 offset:24
    ds_write_b32 v179, v24 offset:28
    ds_write_b32 v179, v25 offset:32
    ds_write_b32 v179, v26 offset:48
    ds_write_b32 v179, v27 offset:52
    ds_write_b32 v179, v28 offset:56
    ds_write_b32 v179, v29 offset:72
    ds_write_b32 v179, v30 offset:76
    ds_write_b32 v179, v31 offset:80
    s_mov_b64 exec, -1
    v_lshlrev_b32 v179, 2, v3
    v_add_u32 v179, s54, v179
    ds_read_b32 v177, v179
    s_mul_i32 s77, s46, 6
    v_lshlrev_b32 v180, 1, v3
    buffer_load_ushort v181, v180, s[12:15], s77 offen
    s_mul_i32 s78, s47, 3
    v_cmp_gt_u32 vcc, s78, v3
    v_mov_b32 v179, 0x7ffffff0
    s_nop 0
    v_cndmask_b32 v180, v179, v180, vcc
    s_waitcnt vmcnt(0)
    v_lshlrev_b32 v181, 16, v181
    v_mov_b32 v179, s76
    s_waitcnt lgkmcnt(0)
    v_fma_f32 v181, v177, v179, v181
    v_cvt_pk_bf16_f32 v181, v181, v181
    s_add_u32 s77, s77, 3200000
    buffer_store_short v181, v180, s[20:23], s77 offen
    v_mfma_f32_32x32x16_bf16 a[0:15], v[68:71], v[124:127], 0
    v_mfma_f32_32x32x16_bf16 a[0:15], v[72:75], v[128:131], a[0:15]
    v_mfma_f32_32x32x16_bf16 a[0:15], v[76:79], v[132:135], a[0:15]
    v_mfma_f32_32x32x16_bf16 a[0:15], v[80:83], v[136:139], a[0:15]
    v_mfma_f32_32x32x16_bf16 a[0:15], v[84:87], v[140:143], a[0:15]
    v_mfma_f32_32x32x16_bf16 a[0:15], v[88:91], v[144:147], a[0:15]
    v_mfma_f32_32x32x16_bf16 a[0:15], v[92:95], v[148:151], a[0:15]
    v_mfma_f32_32x32x16_bf16 a[0:15], v[96:99], v[152:155], a[0:15]
    v_lshlrev_b32 v178, 6, v2
    v_lshl_add_u32 v178, v1, 1, v178
    s_lshl_b32 s78, s73, 6
    v_add_u32 v178, s78, v178
    s_lshl_b32 s79, s64, 8
    v_add_u32 v108, s79, v178
    s_lshl_b32 s79, s65, 8
    v_add_u32 v109, s79, v178
    s_lshl_b32 s79, s66, 8
    v_add_u32 v110, s79, v178
    s_lshl_b32 s79, s67, 8
    v_add_u32 v111, s79, v178
    s_waitcnt lgkmcnt(0)
    s_barrier
    v_lshrrev_b32 v179, 2, v2
    v_mul_u32_u24 v179, 272, v179
    v_lshl_add_u32 v179, v1, 1, v179
    v_add_u32 v179, s78, v179
    s_sub_u32 s79, s64, s86
    s_mul_i32 s79, s79, 272
    s_add_u32 s79, s79, 111872
    v_add_u32 v177, s79, v179
    ds_read_u16 v68, v177 offset:0
    ds_read_u16 v69, v177 offset:272
    ds_read_u16 v70, v177 offset:544
    ds_read_u16 v71, v177 offset:816
    s_sub_u32 s79, s65, s86
    s_mul_i32 s79, s79, 272
    s_add_u32 s79, s79, 111872
    v_add_u32 v177, s79, v179
    ds_read_u16 v72, v177 offset:0
    ds_read_u16 v73, v177 offset:272
    ds_read_u16 v74, v177 offset:544
    ds_read_u16 v75, v177 offset:816
    s_sub_u32 s79, s66, s86
    s_mul_i32 s79, s79, 272
    s_add_u32 s79, s79, 111872
    v_add_u32 v177, s79, v179
    ds_read_u16 v76, v177 offset:0
    ds_read_u16 v77, v177 offset:272
    ds_read_u16 v78, v177 offset:544
    ds_read_u16 v79, v177 offset:816
    s_sub_u32 s79, s67, s86
    s_mul_i32 s79, s79, 272
    s_add_u32 s79, s79, 111872
    v_add_u32 v177, s79, v179
    ds_read_u16 v80, v177 offset:0
    ds_read_u16 v81, v177 offset:272
    ds_read_u16 v82, v177 offset:544
    ds_read_u16 v83, v177 offset:816
    s_lshl_b32 s79, s72, 13
    s_add_u32 s79, s79, 95488
    v_lshl_add_u32 v179, v1, 8, v2
    v_add_u32 v179, s79, v179
    ds_read_b128 v[4:7], v179 offset:0
    ds_read_b128 v[8:11], v179 offset:32
    ds_read_b128 v[12:15], v179 offset:64
    ds_read_b128 v[16:19], v179 offset:96
    ds_read_b128 v[20:23], v179 offset:128
    ds_read_b128 v[24:27], v179 offset:160
    ds_read_b128 v[28:31], v179 offset:192
    ds_read_b128 v[32:35], v179 offset:224
    s_waitcnt lgkmcnt(7)
    v_mfma_f32_32x32x16_bf16 a[0:15], v[4:7], v[36:39], a[0:15]
    s_waitcnt lgkmcnt(6)
    v_mfma_f32_32x32x16_bf16 a[0:15], v[8:11], v[40:43], a[0:15]
    s_waitcnt lgkmcnt(5)
    v_mfma_f32_32x32x16_bf16 a[0:15], v[12:15], v[44:47], a[0:15]
    s_waitcnt lgkmcnt(4)
    v_mfma_f32_32x32x16_bf16 a[0:15], v[16:19], v[48:51], a[0:15]
    s_waitcnt lgkmcnt(3)
    v_mfma_f32_32x32x16_bf16 a[0:15], v[20:23], v[116:119], a[0:15]
    s_waitcnt lgkmcnt(2)
    v_mfma_f32_32x32x16_bf16 a[0:15], v[24:27], v[120:123], a[0:15]
    s_waitcnt lgkmcnt(1)
    v_mfma_f32_32x32x16_bf16 a[0:15], v[28:31], v[100:103], a[0:15]
    s_waitcnt lgkmcnt(0)
    v_mfma_f32_32x32x16_bf16 a[0:15], v[32:35], v[104:107], a[0:15]
    v_lshrrev_b32 v179, 2, v2
    v_mov_b32 v177, 0x7ffffff0
    s_mov_b32 s76, 0xbfb8aa3b
    s_nop 8
    v_accvgpr_read_b32 v52, a0
    v_accvgpr_read_b32 v53, a1
    v_accvgpr_read_b32 v54, a2
    v_accvgpr_read_b32 v55, a3
    v_accvgpr_read_b32 v56, a4
    v_accvgpr_read_b32 v57, a5
    v_accvgpr_read_b32 v58, a6
    v_accvgpr_read_b32 v59, a7
    v_accvgpr_read_b32 v60, a8
    v_accvgpr_read_b32 v61, a9
    v_accvgpr_read_b32 v62, a10
    v_accvgpr_read_b32 v63, a11
    v_accvgpr_read_b32 v64, a12
    v_accvgpr_read_b32 v65, a13
    v_accvgpr_read_b32 v66, a14
    v_accvgpr_read_b32 v67, a15
    v_mul_f32 v124, s76, v52
    v_mul_f32 v125, s76, v53
    v_mul_f32 v126, s76, v54
    v_mul_f32 v127, s76, v55
    v_mul_f32 v128, s76, v56
    v_mul_f32 v129, s76, v57
    v_mul_f32 v130, s76, v58
    v_mul_f32 v131, s76, v59
    v_mul_f32 v132, s76, v60
    v_mul_f32 v133, s76, v61
    v_mul_f32 v134, s76, v62
    v_mul_f32 v135, s76, v63
    v_mul_f32 v136, s76, v64
    v_mul_f32 v137, s76, v65
    v_mul_f32 v138, s76, v66
    v_mul_f32 v139, s76, v67
    v_exp_f32 v124, v124
    v_exp_f32 v125, v125
    v_exp_f32 v126, v126
    v_exp_f32 v127, v127
    v_exp_f32 v128, v128
    v_exp_f32 v129, v129
    v_exp_f32 v130, v130
    v_exp_f32 v131, v131
    v_exp_f32 v132, v132
    v_exp_f32 v133, v133
    v_exp_f32 v134, v134
    v_exp_f32 v135, v135
    v_exp_f32 v136, v136
    v_exp_f32 v137, v137
    v_exp_f32 v138, v138
    v_exp_f32 v139, v139
    v_add_f32 v124, 1.0, v124
    v_add_f32 v125, 1.0, v125
    v_add_f32 v126, 1.0, v126
    v_add_f32 v127, 1.0, v127
    v_add_f32 v128, 1.0, v128
    v_add_f32 v129, 1.0, v129
    v_add_f32 v130, 1.0, v130
    v_add_f32 v131, 1.0, v131
    v_add_f32 v132, 1.0, v132
    v_add_f32 v133, 1.0, v133
    v_add_f32 v134, 1.0, v134
    v_add_f32 v135, 1.0, v135
    v_add_f32 v136, 1.0, v136
    v_add_f32 v137, 1.0, v137
    v_add_f32 v138, 1.0, v138
    v_add_f32 v139, 1.0, v139
    v_rcp_f32 v124, v124
    v_rcp_f32 v125, v125
    v_rcp_f32 v126, v126
    v_rcp_f32 v127, v127
    v_rcp_f32 v128, v128
    v_rcp_f32 v129, v129
    v_rcp_f32 v130, v130
    v_rcp_f32 v131, v131
    v_rcp_f32 v132, v132
    v_rcp_f32 v133, v133
    v_rcp_f32 v134, v134
    v_rcp_f32 v135, v135
    v_rcp_f32 v136, v136
    v_rcp_f32 v137, v137
    v_rcp_f32 v138, v138
    v_rcp_f32 v139, v139
    v_mul_f32 v52, v52, v124
    v_mul_f32 v53, v53, v125
    v_mul_f32 v54, v54, v126
    v_mul_f32 v55, v55, v127
    v_mul_f32 v56, v56, v128
    v_mul_f32 v57, v57, v129
    v_mul_f32 v58, v58, v130
    v_mul_f32 v59, v59, v131
    v_mul_f32 v60, v60, v132
    v_mul_f32 v61, v61, v133
    v_mul_f32 v62, v62, v134
    v_mul_f32 v63, v63, v135
    v_mul_f32 v64, v64, v136
    v_mul_f32 v65, v65, v137
    v_mul_f32 v66, v66, v138
    v_mul_f32 v67, v67, v139
    v_lshlrev_b32 v68, 16, v68
    v_lshlrev_b32 v69, 16, v69
    v_lshlrev_b32 v70, 16, v70
    v_lshlrev_b32 v71, 16, v71
    v_lshlrev_b32 v72, 16, v72
    v_lshlrev_b32 v73, 16, v73
    v_lshlrev_b32 v74, 16, v74
    v_lshlrev_b32 v75, 16, v75
    v_lshlrev_b32 v76, 16, v76
    v_lshlrev_b32 v77, 16, v77
    v_lshlrev_b32 v78, 16, v78
    v_lshlrev_b32 v79, 16, v79
    v_lshlrev_b32 v80, 16, v80
    v_lshlrev_b32 v81, 16, v81
    v_lshlrev_b32 v82, 16, v82
    v_lshlrev_b32 v83, 16, v83
    v_add_f32 v52, v52, v68
    v_add_f32 v53, v53, v69
    v_add_f32 v54, v54, v70
    v_add_f32 v55, v55, v71
    v_add_f32 v56, v56, v72
    v_add_f32 v57, v57, v73
    v_add_f32 v58, v58, v74
    v_add_f32 v59, v59, v75
    v_add_f32 v60, v60, v76
    v_add_f32 v61, v61, v77
    v_add_f32 v62, v62, v78
    v_add_f32 v63, v63, v79
    v_add_f32 v64, v64, v80
    v_add_f32 v65, v65, v81
    v_add_f32 v66, v66, v82
    v_add_f32 v67, v67, v83
    v_cvt_pk_bf16_f32 v52, v52, v52
    v_cvt_pk_bf16_f32 v53, v53, v53
    v_cvt_pk_bf16_f32 v54, v54, v54
    v_cvt_pk_bf16_f32 v55, v55, v55
    v_cvt_pk_bf16_f32 v56, v56, v56
    v_cvt_pk_bf16_f32 v57, v57, v57
    v_cvt_pk_bf16_f32 v58, v58, v58
    v_cvt_pk_bf16_f32 v59, v59, v59
    v_cvt_pk_bf16_f32 v60, v60, v60
    v_cvt_pk_bf16_f32 v61, v61, v61
    v_cvt_pk_bf16_f32 v62, v62, v62
    v_cvt_pk_bf16_f32 v63, v63, v63
    v_cvt_pk_bf16_f32 v64, v64, v64
    v_cvt_pk_bf16_f32 v65, v65, v65
    v_cvt_pk_bf16_f32 v66, v66, v66
    v_cvt_pk_bf16_f32 v67, v67, v67
    v_add_u32 v180, 0, v179
    v_cmp_gt_u32 vcc, s68, v180
    s_nop 1
    v_cndmask_b32 v124, v177, v108, vcc
    buffer_store_short v52, v124, s[20:23], 0 offen offset:0
    v_add_u32 v180, 1, v179
    v_cmp_gt_u32 vcc, s68, v180
    s_nop 1
    v_cndmask_b32 v125, v177, v108, vcc
    buffer_store_short v53, v125, s[20:23], 0 offen offset:256
    v_add_u32 v180, 2, v179
    v_cmp_gt_u32 vcc, s68, v180
    s_nop 1
    v_cndmask_b32 v126, v177, v108, vcc
    buffer_store_short v54, v126, s[20:23], 0 offen offset:512
    v_add_u32 v180, 3, v179
    v_cmp_gt_u32 vcc, s68, v180
    s_nop 1
    v_cndmask_b32 v127, v177, v108, vcc
    buffer_store_short v55, v127, s[20:23], 0 offen offset:768
    v_add_u32 v180, 0, v179
    v_cmp_gt_u32 vcc, s69, v180
    s_nop 1
    v_cndmask_b32 v128, v177, v109, vcc
    buffer_store_short v56, v128, s[20:23], 0 offen offset:0
    v_add_u32 v180, 1, v179
    v_cmp_gt_u32 vcc, s69, v180
    s_nop 1
    v_cndmask_b32 v129, v177, v109, vcc
    buffer_store_short v57, v129, s[20:23], 0 offen offset:256
    v_add_u32 v180, 2, v179
    v_cmp_gt_u32 vcc, s69, v180
    s_nop 1
    v_cndmask_b32 v130, v177, v109, vcc
    buffer_store_short v58, v130, s[20:23], 0 offen offset:512
    v_add_u32 v180, 3, v179
    v_cmp_gt_u32 vcc, s69, v180
    s_nop 1
    v_cndmask_b32 v131, v177, v109, vcc
    buffer_store_short v59, v131, s[20:23], 0 offen offset:768
    v_add_u32 v180, 0, v179
    v_cmp_gt_u32 vcc, s70, v180
    s_nop 1
    v_cndmask_b32 v132, v177, v110, vcc
    buffer_store_short v60, v132, s[20:23], 0 offen offset:0
    v_add_u32 v180, 1, v179
    v_cmp_gt_u32 vcc, s70, v180
    s_nop 1
    v_cndmask_b32 v133, v177, v110, vcc
    buffer_store_short v61, v133, s[20:23], 0 offen offset:256
    v_add_u32 v180, 2, v179
    v_cmp_gt_u32 vcc, s70, v180
    s_nop 1
    v_cndmask_b32 v134, v177, v110, vcc
    buffer_store_short v62, v134, s[20:23], 0 offen offset:512
    v_add_u32 v180, 3, v179
    v_cmp_gt_u32 vcc, s70, v180
    s_nop 1
    v_cndmask_b32 v135, v177, v110, vcc
    buffer_store_short v63, v135, s[20:23], 0 offen offset:768
    v_add_u32 v180, 0, v179
    v_cmp_gt_u32 vcc, s71, v180
    s_nop 1
    v_cndmask_b32 v136, v177, v111, vcc
    buffer_store_short v64, v136, s[20:23], 0 offen offset:0
    v_add_u32 v180, 1, v179
    v_cmp_gt_u32 vcc, s71, v180
    s_nop 1
    v_cndmask_b32 v137, v177, v111, vcc
    buffer_store_short v65, v137, s[20:23], 0 offen offset:256
    v_add_u32 v180, 2, v179
    v_cmp_gt_u32 vcc, s71, v180
    s_nop 1
    v_cndmask_b32 v138, v177, v111, vcc
    buffer_store_short v66, v138, s[20:23], 0 offen offset:512
    v_add_u32 v180, 3, v179
    v_cmp_gt_u32 vcc, s71, v180
    s_nop 1
    v_cndmask_b32 v139, v177, v111, vcc
    buffer_store_short v67, v139, s[20:23], 0 offen offset:768
K2_EXIT:
    s_endpgm
.section .rodata,"a"
.p2align 6
.amdhsa_kernel egnn_prep_kernel
  .amdhsa_next_free_vgpr 184
  .amdhsa_next_free_sgpr 102
  .amdhsa_accum_offset 184
  .amdhsa_group_segment_fixed_size 0
  .amdhsa_kernarg_size 88
  .amdhsa_user_sgpr_count 2
  .amdhsa_user_sgpr_kernarg_segment_ptr 1
  .amdhsa_system_sgpr_workgroup_id_x 1
.end_amdhsa_kernel
.p2align 6
.amdhsa_kernel standalone__cheap_equivariant_egnn__graph_kernel
  .amdhsa_next_free_vgpr 256
  .amdhsa_next_free_sgpr 102
  .amdhsa_accum_offset 192
  .amdhsa_group_segment_fixed_size 0
  .amdhsa_kernarg_size 88
  .amdhsa_user_sgpr_count 2
  .amdhsa_user_sgpr_kernarg_segment_ptr 1
  .amdhsa_system_sgpr_workgroup_id_x 1
.end_amdhsa_kernel
```
